```python
import torch

def _softmax(x, axis=-1):
    return torch.softmax(x, dim=axis)
def _gelu(x):
    return torch.nn.functional.gelu(x, approximate="tanh")
def _silu(x):
    return torch.nn.functional.silu(x)
def _sigmoid(x):
    return torch.sigmoid(x)
def _layernorm(x, axis=-1, eps=1e-5):
    m = x.mean(dim=axis, keepdim=True)
    v = x.var(dim=axis, keepdim=True, unbiased=False)
    return (x - m) / torch.sqrt(v + eps)
def _scatter_add(tgt, idx, src, axis=0):
    return tgt.clone().index_add_(axis, idx, src)
def _segment_sum(src, seg, n):
    out = torch.zeros((n,) + src.shape[1:], dtype=src.dtype)
    return out.index_add_(0, seg, src)
def _pad(x, pw):
    flat = tuple(v for pair in reversed(pw) for v in pair)
    return torch.nn.functional.pad(x, flat)

kernel_name = 'parallel_sum__compressed_kv_cla__glu_gated_geglu__decode'

def setup_inputs():

    _w = (lambda a: (lambda t: t.to(torch.bfloat16) if t.is_floating_point() else t)(torch.as_tensor(a)))
    def _A_setup():
        B, H, Sq, Sk, D, M = 4, 32, 1, 4096, 128, 512
        Dc = 4 * D
        return {
            "x": _w((lambda *s: torch.randn(*s, dtype=torch.bfloat16) * 0.05)(B, Sq, M)),
            "c_kv": _w((lambda *s: torch.randn(*s, dtype=torch.bfloat16) * 0.8)(B, Sk, Dc)),
            "w_q": _w((lambda *s: torch.randn(*s, dtype=torch.bfloat16) * 1.6)(M, H, D) * (M ** -0.5)),
            "w_uk": _w((lambda *s: torch.randn(*s, dtype=torch.bfloat16) * 1.6)(Dc, H, D) * (Dc ** -0.5)),
            "w_uv": _w((lambda *s: torch.randn(*s, dtype=torch.bfloat16) * 0.8)(Dc, H, D) * (Dc ** -0.5)),
            "w_o": _w((lambda *s: torch.randn(*s, dtype=torch.bfloat16) * 0.8)(H, D, M) * ((H * D) ** -0.5)),
        }
    _A_in = _A_setup()

    def _B_setup():
        B, S, Dm, Df = 4, 1, 512, 1792
        return {
            "x": _w((lambda *s: torch.randn(*s, dtype=torch.bfloat16) * 0.05)(B, S, Dm)),
            "w_gate": _w((lambda *s: torch.randn(*s, dtype=torch.bfloat16) * 0.4)(Dm, Df) * (Dm ** -0.5)),
            "w_up": _w((lambda *s: torch.randn(*s, dtype=torch.bfloat16) * 0.4)(Dm, Df) * (Dm ** -0.5)),
            "w_down": _w((lambda *s: torch.randn(*s, dtype=torch.bfloat16) * 0.4)(Df, Dm) * (Df ** -0.5)),
        }
    _B_in = _B_setup()

    return {
        "A_x": _A_in["x"],
        "A_c_kv": _A_in["c_kv"],
        "A_w_q": _A_in["w_q"],
        "A_w_uk": _A_in["w_uk"],
        "A_w_uv": _A_in["w_uv"],
        "A_w_o": _A_in["w_o"],
        "B_x": _B_in["x"],
        "B_w_gate": _B_in["w_gate"],
        "B_w_up": _B_in["w_up"],
        "B_w_down": _B_in["w_down"],
    }

def reference(A_x, A_c_kv, A_w_q, A_w_uk, A_w_uv, A_w_o, B_x, B_w_gate, B_w_up, B_w_down):
    def _A_ref(x, c_kv, w_q, w_uk, w_uv, w_o):
        B, Sq, M = x.shape[0], x.shape[1], x.shape[2]
        Sk = c_kv.shape[1]
        H, D = w_q.shape[1], w_q.shape[2]
        q = torch.einsum("bqm,mhd->bhqd", x, w_q)
        k = torch.einsum("bkc,chd->bhkd", c_kv, w_uk)
        v = torch.einsum("bkc,chd->bhkd", c_kv, w_uv)
        scores = torch.einsum("bhqd,bhkd->bhqk", q, k) * (D ** -0.5)
        off = Sk - Sq
        qi = torch.arange(Sq)[:, None]
        kj = torch.arange(Sk)[None, :]
        cmask = kj <= (qi + off)
        scores = torch.where(cmask[None, None], scores, -1e9)
        p = _softmax(scores, axis=-1)
        ctx = torch.einsum("bhqk,bhkd->bhqd", p, v)
        return torch.einsum("bhqd,hdm->bqm", ctx, w_o)

    def _B_ref(x, w_gate, w_up, w_down):
        g = torch.einsum("bsd,df->bsf", x, w_gate)
        u = torch.einsum("bsd,df->bsf", x, w_up)
        h = _gelu(g) * u
        return torch.einsum("bsf,fd->bsd", h, w_down)

    x = A_x
    xn = _layernorm(x, axis=-1)
    return x + _A_ref(xn, A_c_kv, A_w_q, A_w_uk, A_w_uv, A_w_o) + _B_ref(xn, B_w_gate, B_w_up, B_w_down)
```

```asm
; @launch grid=(256,1,1) block=(448,1,1) lds=163584
.amdgcn_target "amdgcn-amd-amdhsa--gfx950"
.text
.globl parallel_sum__compressed_kv_cla__glu_gated_geglu__decode_kernel
.p2align 8
.type parallel_sum__compressed_kv_cla__glu_gated_geglu__decode_kernel,@function
parallel_sum__compressed_kv_cla__glu_gated_geglu__decode_kernel:
    s_cmp_ge_u32 s2, 256
    s_cbranch_scc1 L_END
    s_load_dwordx16 s[8:23], s[0:1], 0
    s_load_dwordx8 s[24:31], s[0:1], 64
    s_load_dwordx2 s[32:33], s[0:1], 96
    v_readfirstlane_b32 s3, v0
    v_and_b32 v0, 63, v0
    s_and_b32 s34, s2, 7
    s_lshr_b32 s35, s2, 3
    s_lshr_b32 s3, s3, 6
    s_and_b32 s70, s35, 3
    s_lshl2_add_u32 s36, s34, s70
    s_lshl3_add_u32 s43, s70, s34
    s_lshr_b32 s37, s35, 2
    s_lshr_b32 s38, s37, 1
    s_and_b32 s39, s37, 1
    v_and_b32 v1, 15, v0
    v_lshrrev_b32 v2, 4, v0
    v_bfe_u32 v3, v0, 3, 1
    v_and_b32 v4, 7, v0
    v_lshlrev_b32 v5, 4, v0
    v_mov_b32 v15, 27664
    s_cmp_lg_u32 s3, 0
    s_cbranch_scc1 L_NOTA
    s_getpc_b64 s[4:5]
L_PC:
    s_mul_i32 s70, s35, 640
    s_add_u32 s70, s70, L_REST-L_PC
    v_lshl_add_u32 v6, v0, 7, s70
    v_min_u32 v6, L_CODE_END-L_PC-4, v6
    s_mov_b64 exec, 31
    global_load_dword v255, v6, s[4:5]
    s_mov_b64 exec, -1
    v_lshl_add_u32 v8, v3, 2, v2
    v_lshlrev_b32 v7, 4, v4
    v_lshl_add_u32 v6, v8, 16, v7
    s_mov_b32 s73, 8192
    s_lshl_b32 s68, s38, 20
    s_lshl_b32 s70, s36, 8
    s_lshl_b32 s71, s39, 7
    s_add_u32 s69, s70, s71
    s_add_u32 s68, s68, s69
    s_mov_b32 s54, 0x400000
    s_mov_b32 s55, 0x20000
    s_mov_b32 s66, 4096
    s_mov_b32 s67, 0x20000
    s_mov_b32 m0, 16896
    s_waitcnt lgkmcnt(0)
    s_mov_b64 s[64:65], s[8:9]
    buffer_load_dwordx4 v5, s[64:67], 0 offen offset:0 lds
    s_add_u32 m0, m0, 32
    s_nop 0
    buffer_load_dwordx4 v5, s[64:67], 0 offen offset:1024 lds
    s_add_u32 m0, m0, 32
    s_nop 0
    buffer_load_dwordx4 v5, s[64:67], 0 offen offset:2048 lds
    s_add_u32 m0, m0, 32
    s_nop 0
    buffer_load_dwordx4 v5, s[64:67], 0 offen offset:3072 lds
    s_mov_b64 s[52:53], s[12:13]
    buffer_load_dwordx4 v[64:67], v6, s[52:55], s68 offen nt
    s_add_u32 s68, s68, s73
    buffer_load_dwordx4 v[68:71], v6, s[52:55], s68 offen nt
    s_add_u32 s68, s68, s73
    buffer_load_dwordx4 v[72:75], v6, s[52:55], s68 offen nt
    s_add_u32 s68, s68, s73
    buffer_load_dwordx4 v[76:79], v6, s[52:55], s68 offen nt
    s_add_u32 s68, s68, s73
    buffer_load_dwordx4 v[80:83], v6, s[52:55], s68 offen nt
    s_add_u32 s68, s68, s73
    buffer_load_dwordx4 v[84:87], v6, s[52:55], s68 offen nt
    s_add_u32 s68, s68, s73
    buffer_load_dwordx4 v[88:91], v6, s[52:55], s68 offen nt
    s_add_u32 s68, s68, s73
    buffer_load_dwordx4 v[92:95], v6, s[52:55], s68 offen nt
    s_add_u32 s68, s68, 466944
    buffer_load_dwordx4 v[96:99], v6, s[52:55], s68 offen nt
    s_add_u32 s68, s68, s73
    buffer_load_dwordx4 v[100:103], v6, s[52:55], s68 offen nt
    s_add_u32 s68, s68, s73
    buffer_load_dwordx4 v[104:107], v6, s[52:55], s68 offen nt
    s_add_u32 s68, s68, s73
    buffer_load_dwordx4 v[108:111], v6, s[52:55], s68 offen nt
    s_add_u32 s68, s68, s73
    buffer_load_dwordx4 v[112:115], v6, s[52:55], s68 offen nt
    s_add_u32 s68, s68, s73
    buffer_load_dwordx4 v[116:119], v6, s[52:55], s68 offen nt
    s_add_u32 s68, s68, s73
    buffer_load_dwordx4 v[120:123], v6, s[52:55], s68 offen nt
    s_add_u32 s68, s68, s73
    buffer_load_dwordx4 v[124:127], v6, s[52:55], s68 offen nt
    s_load_dword s44, s[32:33], 0
    s_branch L_WA
L_NOTA:
    s_lshr_b32 s40, s34, 1
    s_and_b32 s70, s34, 1
    s_lshr_b32 s41, s35, 1
    s_lshl4_add_u32 s41, s70, s41
    s_and_b32 s42, s35, 1
    s_sub_u32 s74, s3, 3
    s_waitcnt lgkmcnt(0)
    s_cmp_eq_u32 s3, 1
    s_cbranch_scc1 L_WF
    s_cmp_eq_u32 s3, 2
    s_cbranch_scc1 L_WL
    s_cmp_lg_u32 s3, 3
    s_cbranch_scc1 L_WT
    s_mov_b64 exec, 0
    s_branch L_PAD0
L_END:
    s_endpgm
.p2align 12
L_REST:
L_WA:
L_PAD0:
    s_cbranch_execz L_WT
    s_nop 0
    s_mov_b64 s[60:61], s[32:33]
    s_mov_b32 s62, 9179136
    s_mov_b32 s63, 0x20000
    v_and_b32 v9, 1, v1
    v_lshlrev_b32_e64 v9, 6, v9
    v_lshl_add_u32 v9, v2, 4, v9
    v_lshrrev_b32_e64 v10, 2, v1
    v_mul_u32_u24 v11, 1056, v10
    s_lshl_b32 s70, s38, 8
    v_add3_u32 v11, v11, v9, s70
    v_mul_u32_u24 v10, 288, v10
    v_add_u32 v10, v10, v9
    v_mul_u32_u24 v9, 288, v2
    v_lshl_add_u32 v9, v4, 4, v9
    v_lshl_add_u32 v9, v3, 3, v9
    s_setprio 1
    s_waitcnt vmcnt(14)
    s_barrier
    s_waitcnt lgkmcnt(0)
    s_add_u32 s44, s44, 1
    s_and_b32 s45, s44, 0xff
    s_mul_i32 s46, s44, 0x3c6ef362
    s_or_b32 s46, s46, 1
    s_mov_b32 s47, 0xffffff00
    s_mov_b32 s48, 0x05040100
    s_mov_b32 s49, 0x07060302
    v_mov_b32 v12, s45
    s_getreg_b32 s70, hwreg(HW_REG_XCC_ID, 0, 4)
    s_lshl_b32 s70, s70, 8
    s_or_b32 s70, s70, s45
    v_mov_b32_e64 v254, s70
    s_mov_b32 s51, 0xfffff000
    s_lshl_b32 s68, s36, 13
    s_add_u32 s68, s68, 4096
    s_add_u32 s69, s68, 4096
    s_lshl_b32 s6, s37, 10
    s_add_u32 s6, s6, s68
    v_mul_u32_u24 v8, 2112, v4
    v_lshl_add_u32 v8, v3, 6, v8
    v_lshl_add_u32 v8, v2, 4, v8
    s_waitcnt vmcnt(8)
    v_perm_b32 v128, v68, v64, s48
    v_perm_b32 v129, v76, v72, s48
    v_perm_b32 v130, v84, v80, s48
    v_perm_b32 v131, v92, v88, s48
    v_perm_b32 v132, v68, v64, s49
    v_perm_b32 v133, v76, v72, s49
    v_perm_b32 v134, v84, v80, s49
    v_perm_b32 v135, v92, v88, s49
    v_perm_b32 v136, v69, v65, s48
    v_perm_b32 v137, v77, v73, s48
    v_perm_b32 v138, v85, v81, s48
    v_perm_b32 v139, v93, v89, s48
    v_perm_b32 v140, v69, v65, s49
    v_perm_b32 v141, v77, v73, s49
    v_perm_b32 v142, v85, v81, s49
    v_perm_b32 v143, v93, v89, s49
    v_perm_b32 v144, v70, v66, s48
    v_perm_b32 v145, v78, v74, s48
    v_perm_b32 v146, v86, v82, s48
    v_perm_b32 v147, v94, v90, s48
    v_perm_b32 v148, v70, v66, s49
    v_perm_b32 v149, v78, v74, s49
    v_perm_b32 v150, v86, v82, s49
    v_perm_b32 v151, v94, v90, s49
    v_perm_b32 v152, v71, v67, s48
    v_perm_b32 v153, v79, v75, s48
    v_perm_b32 v154, v87, v83, s48
    v_perm_b32 v155, v95, v91, s48
    v_perm_b32 v156, v71, v67, s49
    v_perm_b32 v157, v79, v75, s49
    v_perm_b32 v158, v87, v83, s49
    v_perm_b32 v159, v95, v91, s49
L_fw_1:
    ds_read_b32 v14, v15 offset:0
    s_waitcnt lgkmcnt(0)
    v_cmp_gt_u32 vcc, 4, v14
    s_nop 0
    s_cbranch_vccnz L_fw_1
    ds_read_b128 v[240:243], v11 offset:16896
    ds_read_b128 v[244:247], v11 offset:17024
    s_waitcnt lgkmcnt(1)
    s_nop 0
    v_mfma_f32_16x16x32_bf16 v[208:211], v[240:243], v[128:131], 0
    v_mfma_f32_16x16x32_bf16 v[212:215], v[240:243], v[132:135], 0
    v_mfma_f32_16x16x32_bf16 v[216:219], v[240:243], v[136:139], 0
    v_mfma_f32_16x16x32_bf16 v[220:223], v[240:243], v[140:143], 0
    v_mfma_f32_16x16x32_bf16 v[224:227], v[240:243], v[144:147], 0
    v_mfma_f32_16x16x32_bf16 v[228:231], v[240:243], v[148:151], 0
    v_mfma_f32_16x16x32_bf16 v[232:235], v[240:243], v[152:155], 0
    v_mfma_f32_16x16x32_bf16 v[236:239], v[240:243], v[156:159], 0
    s_waitcnt vmcnt(0) lgkmcnt(0)
    s_nop 0
    v_perm_b32 v192, v100, v96, s48
    v_perm_b32 v193, v108, v104, s48
    v_perm_b32 v194, v116, v112, s48
    v_perm_b32 v195, v124, v120, s48
    v_perm_b32 v196, v100, v96, s49
    v_perm_b32 v197, v108, v104, s49
    v_perm_b32 v198, v116, v112, s49
    v_perm_b32 v199, v124, v120, s49
    v_mfma_f32_16x16x32_bf16 v[208:211], v[244:247], v[192:195], v[208:211]
    v_perm_b32 v200, v101, v97, s48
    v_perm_b32 v201, v109, v105, s48
    v_perm_b32 v202, v117, v113, s48
    v_perm_b32 v203, v125, v121, s48
    v_mfma_f32_16x16x32_bf16 v[212:215], v[244:247], v[196:199], v[212:215]
    v_perm_b32 v204, v101, v97, s49
    v_perm_b32 v205, v109, v105, s49
    v_perm_b32 v206, v117, v113, s49
    v_perm_b32 v207, v125, v121, s49
    v_mfma_f32_16x16x32_bf16 v[216:219], v[244:247], v[200:203], v[216:219]
    v_perm_b32 v192, v102, v98, s48
    v_perm_b32 v193, v110, v106, s48
    v_perm_b32 v194, v118, v114, s48
    v_perm_b32 v195, v126, v122, s48
    v_mfma_f32_16x16x32_bf16 v[220:223], v[244:247], v[204:207], v[220:223]
    v_perm_b32 v196, v102, v98, s49
    v_perm_b32 v197, v110, v106, s49
    v_perm_b32 v198, v118, v114, s49
    v_perm_b32 v199, v126, v122, s49
    v_mfma_f32_16x16x32_bf16 v[224:227], v[244:247], v[192:195], v[224:227]
    v_perm_b32 v200, v103, v99, s48
    v_perm_b32 v201, v111, v107, s48
    v_perm_b32 v202, v119, v115, s48
    v_perm_b32 v203, v127, v123, s48
    v_mfma_f32_16x16x32_bf16 v[228:231], v[244:247], v[196:199], v[228:231]
    v_perm_b32 v204, v103, v99, s49
    v_perm_b32 v205, v111, v107, s49
    v_perm_b32 v206, v119, v115, s49
    v_perm_b32 v207, v127, v123, s49
    v_mfma_f32_16x16x32_bf16 v[232:235], v[244:247], v[200:203], v[232:235]
    s_nop 0
    s_nop 0
    v_mfma_f32_16x16x32_bf16 v[236:239], v[244:247], v[204:207], v[236:239]
    v_add_f32_dpp v248, v209, v208 row_ror:8 row_mask:0xf bank_mask:0x3
    v_add_f32_dpp v249, v213, v212 row_ror:8 row_mask:0xf bank_mask:0x3
    v_add_f32_dpp v250, v217, v216 row_ror:8 row_mask:0xf bank_mask:0x3
    v_add_f32_dpp v251, v221, v220 row_ror:8 row_mask:0xf bank_mask:0x3
    v_add_f32_dpp v248, v224, v225 row_ror:8 row_mask:0xf bank_mask:0xc
    v_add_f32_dpp v249, v228, v229 row_ror:8 row_mask:0xf bank_mask:0xc
    v_add_f32_dpp v250, v232, v233 row_ror:8 row_mask:0xf bank_mask:0xc
L_CHAIN_F:
L_PAD1:
    s_cbranch_execz L_PAD2
    s_nop 0
    s_nop 0
    s_nop 0
    v_add_f32_dpp v251, v236, v237 row_ror:8 row_mask:0xf bank_mask:0xc
    v_and_or_b32 v248, v248, s51, v254
    v_and_or_b32 v249, v249, s47, v12
    v_and_or_b32 v250, v250, s47, v12
    v_and_or_b32 v251, v251, s47, v12
    buffer_store_dwordx4 v[248:251], v5, s[60:63], s6 offen
    s_and_b32 s70, s36, 1
    s_mul_i32 s70, s70, 24576
    s_add_u32 s5, s70, 6819840
    s_mul_i32 s70, s37, 262144
    s_add_u32 s5, s5, s70
    s_lshr_b32 s70, s36, 1
    s_lshl4_add_u32 s70, s37, s70
    s_lshl_b32 s71, s70, 7
    s_lshl_b32 s70, s70, 6
    s_add_u32 s70, s70, 16384
    v_mov_b32 v253, s71
    v_mov_b32_e64 v14, s70
    s_nop 1
    v_mov_b32_dpp v253, v14 quad_perm:[0,1,2,3] row_mask:0xf bank_mask:0xc
    v_mul_u32_u24 v14, 49152, v2
    v_add3_u32 v253, v253, v14, v7
    v_mov_b32 v252, 0
    v_lshlrev_b32 v11, 2, v1
    v_lshl_add_u32 v255, v2, 7, v11
    s_mul_i32 s74, s37, 2688
    s_add_u32 s74, s74, 1052672
    s_waitcnt vmcnt(0)
    s_nop 0
    buffer_load_dwordx4 v[16:19], v5, s[60:63], s68 offen offset:0 sc1
    buffer_load_dwordx4 v[20:23], v5, s[60:63], s68 offen offset:1024 sc1
    buffer_load_dwordx4 v[24:27], v5, s[60:63], s68 offen offset:2048 sc1
    buffer_load_dwordx4 v[28:31], v5, s[60:63], s68 offen offset:3072 sc1
    buffer_load_dwordx4 v[32:35], v5, s[60:63], s69 offen offset:0 sc1
    buffer_load_dwordx4 v[36:39], v5, s[60:63], s69 offen offset:1024 sc1
    buffer_load_dwordx4 v[40:43], v5, s[60:63], s69 offen offset:2048 sc1
    buffer_load_dwordx4 v[44:47], v5, s[60:63], s69 offen offset:3072 sc1
    s_mov_b32 s72, 65536
    s_mov_b32 s7, 0xff
L_fw_4:
    ds_read_b32 v14, v15 offset:4
    s_waitcnt lgkmcnt(0)
    v_cmp_gt_u32 vcc, 1, v14
    s_nop 0
    s_cbranch_vccnz L_fw_4
    ds_read_b128 v[128:131], v8 offset:0
    ds_read_b128 v[160:163], v8 offset:128
    ds_read_b128 v[132:135], v8 offset:256
    ds_read_b128 v[164:167], v8 offset:384
    ds_read_b128 v[136:139], v8 offset:512
    ds_read_b128 v[168:171], v8 offset:640
    ds_read_b128 v[140:143], v8 offset:768
    ds_read_b128 v[172:175], v8 offset:896
    ds_read_b128 v[144:147], v8 offset:1056
    ds_read_b128 v[176:179], v8 offset:1184
    ds_read_b128 v[148:151], v8 offset:1312
    ds_read_b128 v[180:183], v8 offset:1440
    s_waitcnt lgkmcnt(4)
    ds_read_b128 v[152:155], v8 offset:1568
    ds_read_b128 v[184:187], v8 offset:1696
    ds_read_b128 v[156:159], v8 offset:1824
    ds_read_b128 v[188:191], v8 offset:1952
L_go_2:
    s_waitcnt vmcnt(7)
    v_xor_b32 v16, v16, v12
    v_xor_b32 v17, v17, v12
    v_xor_b32 v18, v18, v12
    v_xor_b32 v19, v19, v12
    v_or_b32_e64 v13, v16, v17
    v_or3_b32 v13, v13, v18, v19
    v_xor_b32 v14, v16, v254
    v_and_b32 v16, s51, v16
    s_waitcnt vmcnt(6)
    v_xor_b32 v20, v20, v12
    v_xor_b32 v21, v21, v12
    v_xor_b32 v22, v22, v12
    v_xor_b32_e64 v23, v23, v12
    v_or3_b32 v13, v13, v20, v21
    v_or3_b32 v13, v13, v22, v23
    v_bitop3_b32 v14, v20, v14, v254 bitop3:0xde
    v_and_b32 v20, s51, v20
    s_waitcnt vmcnt(5)
    v_xor_b32 v24, v24, v12
    v_xor_b32 v25, v25, v12
    v_xor_b32 v26, v26, v12
    v_xor_b32 v27, v27, v12
    v_or3_b32 v13, v13, v24, v25
    v_or3_b32 v13, v13, v26, v27
    v_bitop3_b32 v14, v24, v14, v254 bitop3:0xde
    v_and_b32_e64 v24, s51, v24
    v_pk_add_f32 v[52:53], v[16:17], v[24:25]
    v_pk_add_f32 v[54:55], v[18:19], v[26:27]
    s_waitcnt vmcnt(4)
    v_xor_b32 v28, v28, v12
    v_xor_b32 v29, v29, v12
    v_xor_b32 v30, v30, v12
    v_xor_b32_e64 v31, v31, v12
    v_or3_b32 v13, v13, v28, v29
    v_or3_b32 v13, v13, v30, v31
    v_bitop3_b32 v14, v28, v14, v254 bitop3:0xde
    v_and_b32_e64 v28, s51, v28
    v_pk_add_f32 v[56:57], v[20:21], v[28:29]
    v_pk_add_f32 v[58:59], v[22:23], v[30:31]
    s_waitcnt vmcnt(3)
    v_xor_b32 v32, v32, v12
    v_xor_b32 v33, v33, v12
    v_xor_b32 v34, v34, v12
    v_xor_b32_e64 v35, v35, v12
    v_or3_b32 v13, v13, v32, v33
    v_or3_b32 v13, v13, v34, v35
    v_bitop3_b32 v14, v32, v14, v254 bitop3:0xde
    v_and_b32_e64 v32, s51, v32
    v_pk_add_f32 v[52:53], v[52:53], v[32:33]
    v_pk_add_f32 v[54:55], v[54:55], v[34:35]
    s_waitcnt vmcnt(2)
    v_xor_b32 v36, v36, v12
    v_xor_b32 v37, v37, v12
    v_xor_b32 v38, v38, v12
    v_xor_b32_e64 v39, v39, v12
    v_or3_b32 v13, v13, v36, v37
    v_or3_b32 v13, v13, v38, v39
    v_bitop3_b32 v14, v36, v14, v254 bitop3:0xde
    v_and_b32_e64 v36, s51, v36
    v_pk_add_f32 v[56:57], v[56:57], v[36:37]
    v_pk_add_f32 v[58:59], v[58:59], v[38:39]
    s_waitcnt vmcnt(1)
    v_xor_b32 v40, v40, v12
    v_xor_b32 v41, v41, v12
    v_xor_b32 v42, v42, v12
    v_xor_b32_e64 v43, v43, v12
    v_or3_b32 v13, v13, v40, v41
    v_or3_b32 v13, v13, v42, v43
    v_bitop3_b32 v14, v40, v14, v254 bitop3:0xde
    v_and_b32_e64 v40, s51, v40
    v_pk_add_f32 v[52:53], v[52:53], v[40:41]
    v_pk_add_f32 v[54:55], v[54:55], v[42:43]
    s_waitcnt vmcnt(0)
    v_xor_b32 v44, v44, v12
    v_xor_b32 v45, v45, v12
    v_xor_b32 v46, v46, v12
    v_xor_b32_e64 v47, v47, v12
    v_or3_b32 v13, v13, v44, v45
    v_or3_b32 v13, v13, v46, v47
    v_bitop3_b32 v14, v44, v14, v254 bitop3:0xde
    v_and_b32_e64 v44, s51, v44
    v_pk_add_f32 v[56:57], v[56:57], v[44:45]
    v_pk_add_f32 v[58:59], v[58:59], v[46:47]
    v_and_b32_e64 v13, s7, v13
    v_cvt_pk_bf16_f32 v52, v52, v53
    v_cmp_ne_u32_e64 vcc, 0, v13
    v_cvt_pk_bf16_f32 v53, v54, v55
    v_cvt_pk_bf16_f32 v54, v56, v57
    v_cvt_pk_bf16_f32 v55, v58, v59
    ds_write_b64 v9, v[52:53] offset:25216
    ds_write_b64 v9, v[54:55] offset:25344
L_PAD2:
    s_cbranch_execz L_PAD3
    s_nop 0
    s_cbranch_vccnz L_gor_3
    ds_read_b128 v[240:243], v10 offset:25216
    ds_read_b128 v[244:247], v10 offset:25344
    v_readfirstlane_b32 s50, v14
    s_waitcnt lgkmcnt(0)
    s_and_b32 s50, s50, 0xf00
    s_cbranch_scc1 L_rs_5
L_rs_6:
    v_mfma_f32_16x16x32_bf16 v[208:211], v[240:243], v[128:131], 0
    v_mfma_f32_16x16x32_bf16 v[208:211], v[244:247], v[160:163], v[208:211]
    s_nop 1
    v_mfma_f32_16x16x32_bf16 v[212:215], v[240:243], v[132:135], 0
    s_nop 1
    v_mfma_f32_16x16x32_bf16 v[212:215], v[244:247], v[164:167], v[212:215]
    s_nop 1
    v_mfma_f32_16x16x32_bf16 v[216:219], v[240:243], v[136:139], 0
    v_add_f32_dpp v16, v209, v208 row_ror:8 row_mask:0xf bank_mask:0xf
    s_nop 0
    v_mfma_f32_16x16x32_bf16 v[216:219], v[244:247], v[168:171], v[216:219]
    s_nop 1
    v_mfma_f32_16x16x32_bf16 v[220:223], v[240:243], v[140:143], 0
    v_add_f32_dpp v17, v213, v212 row_ror:8 row_mask:0xf bank_mask:0xf
    v_cvt_pk_bf16_f32 v248, v16, v17
    v_mfma_f32_16x16x32_bf16 v[220:223], v[244:247], v[172:175], v[220:223]
    s_nop 1
    v_mfma_f32_16x16x32_bf16 v[224:227], v[240:243], v[144:147], 0
    v_add_f32_dpp v18, v217, v216 row_ror:8 row_mask:0xf bank_mask:0xf
    s_nop 0
    v_mfma_f32_16x16x32_bf16 v[224:227], v[244:247], v[176:179], v[224:227]
    s_nop 1
    v_mfma_f32_16x16x32_bf16 v[228:231], v[240:243], v[148:151], 0
    v_add_f32_dpp v19, v221, v220 row_ror:8 row_mask:0xf bank_mask:0xf
    v_cvt_pk_bf16_f32 v249, v18, v19
    v_mfma_f32_16x16x32_bf16 v[228:231], v[244:247], v[180:183], v[228:231]
    s_nop 1
    v_mfma_f32_16x16x32_bf16 v[232:235], v[240:243], v[152:155], 0
    v_add_f32_dpp v20, v225, v224 row_ror:8 row_mask:0xf bank_mask:0xf
    s_nop 0
    v_mfma_f32_16x16x32_bf16 v[232:235], v[244:247], v[184:187], v[232:235]
    s_nop 1
    v_mfma_f32_16x16x32_bf16 v[236:239], v[240:243], v[156:159], 0
    v_add_f32_dpp v21, v229, v228 row_ror:8 row_mask:0xf bank_mask:0xf
    v_cvt_pk_bf16_f32 v250, v20, v21
    v_mfma_f32_16x16x32_bf16 v[236:239], v[244:247], v[188:191], v[236:239]
    s_nop 1
    v_add_f32_dpp v22, v233, v232 row_ror:8 row_mask:0xf bank_mask:0xf
    s_nop 4
    v_add_f32_dpp v23, v237, v236 row_ror:8 row_mask:0xf bank_mask:0xf
    v_cvt_pk_bf16_f32 v251, v22, v23
    v_add3_u32 v16, v248, v249, v250
    v_add_u32 v16, v16, v251
    v_mov_b32_dpp v249, v252 quad_perm:[0,1,2,3] row_mask:0xf bank_mask:0x4
    v_mov_b32_dpp v250, v252 quad_perm:[0,1,2,3] row_mask:0xf bank_mask:0x4
    v_add_u32_dpp v16, v16, v16 row_shl:4 row_mask:0xf bank_mask:0x1
    v_sub_u32_e64 v16, s46, v16
    v_mov_b32_dpp v251, v252 quad_perm:[0,1,2,3] row_mask:0xf bank_mask:0x4
    s_mov_b32 exec_lo, 0x0fff0fff
    v_mov_b32_dpp v248, v16 row_shr:8 row_mask:0xf bank_mask:0x4
    s_mov_b32 exec_hi, 0x0fff0fff
    buffer_store_dwordx4 v[248:251], v253, s[60:63], s5 offen sc1
    s_mov_b64 exec, -1
    s_lshl_b32 s21, s37, 2
    s_cmp_eq_u32 s36, s21
    s_cbranch_scc1 L_INIT
L_INITD:
    s_add_u32 s70, s50, 1
    v_mov_b32 v14, s70
    ds_write_b32 v15, v14 offset:8
    s_mov_b64 s[52:53], s[16:17]
    s_lshl3_add_u32 s6, s36, s37
    s_lshl_b32 s6, s6, 11
    s_add_u32 s6, s6, 266240
    s_lshl4_add_u32 s75, s38, s39
    s_lshl_b32 s75, s75, 16
    s_lshl_b32 s70, s36, 8
    s_add_u32 s75, s75, s70
    v_lshlrev_b32 v9, 1, v2
    v_xor_b32 v9, v9, v1
    v_lshlrev_b32 v8, 17, v2
    v_lshl_add_u32 v8, v9, 4, v8
    v_lshlrev_b32 v58, 2, v1
    v_mov_b32 v59, s46
    v_mov_b32_e64 v13, 1
    s_mov_b32 m0, 28416
    s_mov_b32 s73, 1088
    s_barrier
    s_barrier
    s_barrier
    buffer_load_dwordx4 v8, s[52:55], s75 offen nt lds
    s_add_u32 m0, m0, s73
    s_add_u32 s75, s75, 524288
    buffer_load_dwordx4 v8, s[52:55], s75 offen nt lds
    s_add_u32 m0, m0, s73
    s_sub_u32 s75, s75, 516096
    buffer_load_dwordx4 v8, s[52:55], s75 offen nt lds
    s_add_u32 m0, m0, s73
    s_add_u32 s75, s75, 524288
    buffer_load_dwordx4 v8, s[52:55], s75 offen nt lds
    s_add_u32 m0, m0, s73
    s_sub_u32 s75, s75, 516096
    buffer_load_dwordx4 v8, s[52:55], s75 offen nt lds
    s_add_u32 m0, m0, s73
    s_add_u32 s75, s75, 524288
    buffer_load_dwordx4 v8, s[52:55], s75 offen nt lds
    s_add_u32 m0, m0, s73
    s_sub_u32 s75, s75, 516096
    buffer_load_dwordx4 v8, s[52:55], s75 offen nt lds
    s_add_u32 m0, m0, s73
    s_add_u32 s75, s75, 524288
    buffer_load_dwordx4 v8, s[52:55], s75 offen nt lds
    s_add_u32 m0, m0, s73
    s_sub_u32 s75, s75, 516096
    s_barrier
    s_barrier
L_fw_7:
    ds_read_b32 v14, v15 offset:16
    s_waitcnt lgkmcnt(0)
    v_cmp_gt_u32_e64 vcc, 5, v14
    s_nop 0
    s_cbranch_vccnz L_fw_7
    s_cmp_eq_u32 s36, s21
    s_cbranch_scc1 L_CLR
L_CLRD:
    buffer_load_dwordx4 v[16:19], v5, s[60:63], s6 offen sc1
    buffer_load_dwordx4 v[20:23], v5, s[60:63], s6 offen offset:1024 sc1
    buffer_load_dwordx4 v8, s[52:55], s75 offen nt lds
    s_add_u32 m0, m0, s73
    s_add_u32 s75, s75, 524288
    buffer_load_dwordx4 v8, s[52:55], s75 offen nt lds
    s_add_u32 m0, m0, s73
    s_sub_u32 s75, s75, 516096
    buffer_load_dwordx4 v8, s[52:55], s75 offen nt lds
    s_add_u32 m0, m0, s73
    s_add_u32 s75, s75, 524288
    buffer_load_dwordx4 v8, s[52:55], s75 offen nt lds
    s_add_u32 m0, m0, s73
    s_sub_u32 s75, s75, 516096
    buffer_load_dwordx4 v8, s[52:55], s75 offen nt lds
    s_add_u32 m0, m0, s73
    s_add_u32 s75, s75, 524288
    buffer_load_dwordx4 v8, s[52:55], s75 offen nt lds
    s_add_u32 m0, m0, s73
    s_sub_u32 s75, s75, 516096
    buffer_load_dwordx4 v8, s[52:55], s75 offen nt lds
    s_add_u32 m0, m0, s73
    s_add_u32 s75, s75, 524288
    buffer_load_dwordx4 v8, s[52:55], s75 offen nt lds
    s_waitcnt vmcnt(0)
    ds_write_b32 v15, v13 offset:24
    s_endpgm
L_rs_5:
    buffer_store_dwordx4 v[248:251], v5, s[60:63], s6 offen sc1
    s_waitcnt vmcnt(0)
    s_branch L_rs_6
L_gor_3:
    s_waitcnt lgkmcnt(0)
    s_sub_u32 s72, s72, 1
    s_cselect_b32 s7, 0, s7
    s_cmp_lg_u32 s72, 65533
    s_cbranch_scc1 L_rs_8
    s_nop 0
    buffer_store_dwordx4 v[248:251], v5, s[60:63], s6 offen sc1
L_rs_8:
    buffer_load_dwordx4 v[16:19], v5, s[60:63], s68 offen offset:0 sc1
    buffer_load_dwordx4 v[20:23], v5, s[60:63], s68 offen offset:1024 sc1
    buffer_load_dwordx4 v[24:27], v5, s[60:63], s68 offen offset:2048 sc1
    buffer_load_dwordx4 v[28:31], v5, s[60:63], s68 offen offset:3072 sc1
    buffer_load_dwordx4 v[32:35], v5, s[60:63], s69 offen offset:0 sc1
    buffer_load_dwordx4 v[36:39], v5, s[60:63], s69 offen offset:1024 sc1
L_PAD3:
    s_cbranch_execz L_PAD10
    s_nop 0
    buffer_load_dwordx4 v[40:43], v5, s[60:63], s69 offen offset:2048 sc1
    buffer_load_dwordx4 v[44:47], v5, s[60:63], s69 offen offset:3072 sc1
    s_branch L_go_2
L_INIT:
    buffer_store_dword v252, v255, s[60:63], s74 offen offset:0 sc1
    buffer_store_dword v252, v255, s[60:63], s74 offen offset:512 sc1
    buffer_store_dword v252, v255, s[60:63], s74 offen offset:1024 sc1
    buffer_store_dword v252, v255, s[60:63], s74 offen offset:1536 sc1
    buffer_store_dword v252, v255, s[60:63], s74 offen offset:2048 sc1
    s_waitcnt vmcnt(0)
    s_branch L_INITD
L_CLR:
    buffer_store_dword v59, v58, s[60:63], s74 offen offset:2560 sc1
    s_branch L_CLRD
L_WT:
    s_mov_b64 exec, -1
    s_mov_b64 s[60:61], s[32:33]
    s_mov_b32 s62, 9179136
    s_mov_b32 s63, 0x20000
    s_mul_i32 s70, s74, 1056
    v_add_u32 v6, s70, v5
    v_mov_b32_e64 v12, 1
    s_barrier
    ds_read_b128 v[16:19], v6 offset:16896
    s_waitcnt lgkmcnt(0)
    v_lshlrev_b32 v20, 16, v16
    v_and_b32 v21, 0xffff0000, v16
    v_lshlrev_b32_e64 v22, 16, v17
    v_and_b32 v23, 0xffff0000, v17
    v_lshlrev_b32_e64 v24, 16, v18
    v_and_b32 v25, 0xffff0000, v18
    v_lshlrev_b32_e64 v26, 16, v19
    v_and_b32 v27, 0xffff0000, v19
    v_add_f32 v28, v20, v21
    v_add_f32 v29, v22, v23
    v_add_f32 v30, v24, v25
    v_add_f32 v31, v26, v27
    v_add_f32 v28, v28, v29
    v_add_f32 v30, v30, v31
    v_add_f32 v28, v28, v30
    s_nop 1
    v_add_f32_dpp v28, v28, v28 row_ror:1 row_mask:0xf bank_mask:0xf
    s_nop 1
    v_add_f32_dpp v28, v28, v28 row_ror:2 row_mask:0xf bank_mask:0xf
    s_nop 1
    v_add_f32_dpp v28, v28, v28 row_ror:4 row_mask:0xf bank_mask:0xf
    s_nop 1
    v_add_f32_dpp v28, v28, v28 row_ror:8 row_mask:0xf bank_mask:0xf
    s_nop 1
    v_add_f32_dpp v28, v28, v28 row_bcast:15 row_mask:0xa bank_mask:0xf
    s_nop 1
    v_add_f32_dpp v28, v28, v28 row_bcast:31 row_mask:0xc bank_mask:0xf
    s_nop 0
    v_readlane_b32 s70, v28, 63
    v_mov_b32 v29, 0x3b000000
    s_nop 0
    v_mul_f32 v29, s70, v29
    v_sub_f32 v30, v20, v29
    v_mul_f32 v28, v30, v30
    v_sub_f32 v30, v21, v29
    v_fmac_f32 v28, v30, v30
    v_sub_f32 v30, v22, v29
    v_fmac_f32 v28, v30, v30
    v_sub_f32 v30, v23, v29
    v_fmac_f32 v28, v30, v30
    v_sub_f32 v30, v24, v29
    v_fmac_f32 v28, v30, v30
    v_sub_f32 v30, v25, v29
    v_fmac_f32 v28, v30, v30
    v_sub_f32 v30, v26, v29
    v_fmac_f32 v28, v30, v30
    v_sub_f32 v30, v27, v29
    v_fmac_f32_e64 v28, v30, v30
    s_nop 1
    v_add_f32_dpp v28, v28, v28 row_ror:1 row_mask:0xf bank_mask:0xf
    s_nop 1
    v_add_f32_dpp v28, v28, v28 row_ror:2 row_mask:0xf bank_mask:0xf
    s_nop 1
    v_add_f32_dpp v28, v28, v28 row_ror:4 row_mask:0xf bank_mask:0xf
    s_nop 1
    v_add_f32_dpp v28, v28, v28 row_ror:8 row_mask:0xf bank_mask:0xf
    s_nop 1
    v_add_f32_dpp v28, v28, v28 row_bcast:15 row_mask:0xa bank_mask:0xf
    s_nop 1
    v_add_f32_dpp v28, v28, v28 row_bcast:31 row_mask:0xc bank_mask:0xf
    s_nop 0
    v_readlane_b32 s70, v28, 63
    v_mov_b32 v30, 0x3b000000
    s_nop 0
    v_mul_f32 v30, s70, v30
    v_cvt_pk_bf16_f32 v29, v29, v30
    v_and_b32 v30, 0xffff0000, v29
    v_lshlrev_b32_e64 v29, 16, v29
    v_add_f32 v30, 0x3727c5ac, v30
    v_cvt_pk_bf16_f32 v30, v30, v30
    v_and_b32 v30, 0xffff0000, v30
    v_sqrt_f32 v30, v30
    s_nop 0
    v_cvt_pk_bf16_f32 v30, v30, v30
    v_and_b32 v30, 0xffff0000, v30
    v_rcp_f32 v30, v30
    v_sub_f32 v20, v20, v29
    v_sub_f32 v21, v21, v29
    v_sub_f32 v22, v22, v29
    v_sub_f32 v23, v23, v29
    v_sub_f32 v24, v24, v29
    v_sub_f32 v25, v25, v29
    v_sub_f32 v26, v26, v29
    v_sub_f32_e64 v27, v27, v29
    v_cvt_pk_bf16_f32 v16, v20, v21
    v_cvt_pk_bf16_f32 v17, v22, v23
    v_cvt_pk_bf16_f32 v18, v24, v25
    v_cvt_pk_bf16_f32 v19, v26, v27
    v_lshlrev_b32_e64 v20, 16, v16
    v_and_b32 v21, 0xffff0000, v16
    v_lshlrev_b32_e64 v22, 16, v17
    v_and_b32 v23, 0xffff0000, v17
    v_lshlrev_b32_e64 v24, 16, v18
    v_and_b32 v25, 0xffff0000, v18
    v_lshlrev_b32_e64 v26, 16, v19
    v_and_b32 v27, 0xffff0000, v19
    v_mul_f32 v20, v20, v30
    v_mul_f32 v21, v21, v30
    v_mul_f32 v22, v22, v30
    v_mul_f32 v23, v23, v30
    v_mul_f32 v24, v24, v30
    v_mul_f32 v25, v25, v30
    v_mul_f32 v26, v26, v30
    v_mul_f32 v27, v27, v30
    v_cvt_pk_bf16_f32 v16, v20, v21
    v_cvt_pk_bf16_f32 v17, v22, v23
    v_cvt_pk_bf16_f32 v18, v24, v25
    v_cvt_pk_bf16_f32 v19, v26, v27
    ds_write_b128 v6, v[16:19] offset:16896
    s_mov_b64 exec, 1
    ds_add_u32 v15, v12 offset:0
    s_mov_b64 exec, -1
    s_load_dword s44, s[32:33], 0
    s_mov_b64 exec, 0
    s_branch L_CHAIN_T
L_BACK_T:
    s_mov_b64 exec, -1
    s_waitcnt lgkmcnt(0)
    s_add_u32 s44, s44, 1
    s_and_b32 s45, s44, 0xff
    s_mul_i32 s46, s44, 0x3c6ef362
    s_or_b32 s46, s46, 1
    s_mov_b32 s47, 0xffffff00
    s_mov_b32 s48, 0x05040100
    s_mov_b32 s49, 0x07060302
    s_lshl1_add_u32 s70, s40, s42
    s_mul_i32 s70, s70, 24576
    s_add_u32 s70, s70, 6819840
    s_lshl_b32 s68, s74, 9
    s_add_u32 s68, s68, s70
    s_add_u32 s20, s68, 264192
    s_add_u32 s21, s20, 264192
    s_add_u32 s22, s21, 264192
    s_lshl_b32 s69, s74, 8
    s_add_u32 s69, s69, s70
    s_add_u32 s69, s69, 16384
    s_add_u32 s23, s69, 526336
    s_lshl_b32 s75, s46, 5
    v_lshrrev_b32 v10, 1, v2
    v_and_b32 v11, 1, v2
    v_lshlrev_b32_e64 v8, 4, v1
    v_lshl_add_u32 v8, v10, 8, v8
    v_mul_u32_u24 v13, 1056768, v11
    v_add_u32 v8, v8, v13
    v_lshlrev_b32 v9, 4, v4
    v_lshl_add_u32 v9, v10, 7, v9
    v_lshl_add_u32 v13, v11, 2, v3
    v_mul_u32_u24 v13, 263168, v13
    v_add_u32_e64 v9, v9, v13
L_CHAIN_T:
L_PAD4:
    s_cbranch_execz L_PAD5
    s_nop 0
    v_lshl_add_u32 v6, v10, 1, v3
    s_lshl_b32 s70, s74, 2
    v_add_u32 v6, s70, v6
    v_mul_u32_u24 v6, 1056, v6
    v_lshl_add_u32 v6, v4, 4, v6
    v_lshl_add_u32 v6, v11, 9, v6
    v_mul_u32_u24 v7, 1056, v1
    v_lshl_add_u32 v7, v2, 4, v7
    s_mov_b32 s72, 65536
    s_mul_i32 s70, s74, 16896
    s_add_u32 s70, s70, 28416
    v_add_u32_e64 v40, s70, v7
    v_add_u32 v11, 67584, v40
    v_lshrrev_b32_e64 v41, 2, v0
    v_mul_u32_u24 v41, 1056, v41
    v_and_b32_e64 v42, 3, v0
    v_lshl_add_u32 v41, v42, 3, v41
    s_lshl_b32 s70, s74, 8
    s_add_u32 s70, s70, 28416
    v_add_u32_e64 v41, s70, v41
    s_xor_b32 s70, s74, 0
    s_mul_i32 s70, s70, 16896
    v_add_u32 v44, s70, v41
    s_xor_b32 s70, s74, 1
    s_mul_i32 s70, s70, 16896
    v_add_u32 v45, s70, v41
    s_xor_b32 s70, s74, 2
    s_mul_i32 s70, s70, 16896
    v_add_u32 v46, s70, v41
    s_xor_b32 s70, s74, 3
    s_mul_i32 s70, s70, 16896
    v_add_u32 v47, s70, v41
    s_lshl_b32 s70, s74, 10
    v_add_u32_e64 v10, s70, v5
    s_mov_b32 s50, 0x3e0293ee
    v_lshlrev_b32_e64 v14, 20, v2
    v_lshl_add_u32 v14, v1, 4, v14
    s_lshl2_add_u32 s70, s42, s74
    s_lshl2_add_u32 s70, s70, s40
    s_lshl_b32 s70, s70, 13
    s_add_u32 s70, s70, 1576960
    s_lshl_b32 s6, s41, 8
    s_add_u32 s6, s6, s70
    s_add_u32 s16, s6, 0x40000
    s_add_u32 s17, s16, 0x40000
    s_add_u32 s18, s17, 0x40000
    s_lshl2_add_u32 s70, s42, s40
    s_lshl_b32 s70, s70, 11
    s_lshl_b32 s7, s41, 6
    s_add_u32 s7, s7, s70
    s_add_u32 s7, s7, 5771264
    s_lshl2_add_u32 s70, s36, s38
    s_lshl2_add_u32 s70, s70, s74
    s_lshl_b32 s70, s70, 13
    s_add_u32 s8, s70, 1576960
    s_lshl_b32 s70, s39, 7
    s_add_u32 s8, s8, s70
    s_lshl2_add_u32 s70, s36, s74
    s_lshl_b32 s70, s70, 11
    s_add_u32 s9, s70, 5771264
    s_lshl_b32 s10, 0x11111111, s38
    s_mov_b32 s11, s10
    s_sub_u32 s24, 0, s39
    s_mov_b32 s25, s24
    s_mov_b32 s26, 0xaaaaaaaa
    s_mov_b32 s27, s26
    v_lshlrev_b32_e64 v4, 4, v4
    v_lshl_add_u32 v3, v3, 10, v4
    v_lshl_add_u32 v3, v2, 11, v3
    v_lshlrev_b32_e64 v4, 4, v1
    v_lshl_add_u32 v4, v2, 9, v4
    v_lshlrev_b32 v1, 2, v1
    s_lshl1_add_u32 s70, s40, s42
    s_mul_i32 s12, s70, 2048
    s_add_u32 s12, s12, 790528
    s_and_b32 s70, s36, 1
    s_lshl1_add_u32 s70, s74, s70
    s_mul_i32 s70, s70, 16
    s_lshr_b32 s13, s36, 1
    s_and_b32 s13, s13, 15
    s_add_u32 s13, s13, s70
    s_lshl_b32 s13, s13, 7
    s_add_u32 s13, s13, 790528
    s_load_dword s14, s[32:33], s13
L_fw_9:
    ds_read_b32 v13, v15 offset:4
    s_waitcnt lgkmcnt(0)
    v_cmp_gt_u32_e64 vcc, 2, v13
    s_nop 0
    s_cbranch_vccnz L_fw_9
    ds_read_b128 v[64:67], v40 offset:0
    ds_read_b128 v[68:71], v40 offset:64
    ds_read_b128 v[72:75], v40 offset:128
    ds_read_b128 v[76:79], v40 offset:192
    ds_read_b128 v[80:83], v40 offset:256
    ds_read_b128 v[84:87], v40 offset:320
    ds_read_b128 v[88:91], v40 offset:384
    ds_read_b128 v[92:95], v40 offset:448
    s_waitcnt lgkmcnt(4)
    s_nop 0
    ds_read_b128 v[96:99], v40 offset:512
    ds_read_b128 v[100:103], v40 offset:576
    ds_read_b128 v[104:107], v40 offset:640
    ds_read_b128 v[108:111], v40 offset:704
    ds_read_b128 v[112:115], v40 offset:768
    ds_read_b128 v[116:119], v40 offset:832
    ds_read_b128 v[120:123], v40 offset:896
    ds_read_b128 v[124:127], v40 offset:960
    s_waitcnt lgkmcnt(4)
    s_nop 0
    ds_read_b64_tr_b16 v[128:129], v44 offset:0
    ds_read_b64_tr_b16 v[132:133], v44 offset:32
    ds_read_b64_tr_b16 v[136:137], v44 offset:64
    ds_read_b64_tr_b16 v[140:141], v44 offset:96
    ds_read_b64_tr_b16 v[144:145], v44 offset:128
    ds_read_b64_tr_b16 v[148:149], v44 offset:160
    ds_read_b64_tr_b16 v[152:153], v44 offset:192
    ds_read_b64_tr_b16 v[156:157], v44 offset:224
    ds_read_b64_tr_b16 v[160:161], v45 offset:0
    ds_read_b64_tr_b16 v[164:165], v45 offset:32
    s_waitcnt lgkmcnt(4)
    s_nop 0
    ds_read_b64_tr_b16 v[168:169], v46 offset:0
    ds_read_b64_tr_b16 v[172:173], v46 offset:32
    ds_read_b64_tr_b16 v[176:177], v47 offset:0
    ds_read_b64_tr_b16 v[180:181], v47 offset:32
    ds_read_b64_tr_b16 v[184:185], v45 offset:64
    ds_read_b64_tr_b16 v[188:189], v45 offset:96
    ds_read_b64_tr_b16 v[192:193], v46 offset:64
    ds_read_b64_tr_b16 v[196:197], v46 offset:96
    ds_read_b64_tr_b16 v[200:201], v47 offset:64
    ds_read_b64_tr_b16 v[204:205], v47 offset:96
    s_waitcnt lgkmcnt(4)
    s_nop 0
    ds_read_b64_tr_b16 v[208:209], v45 offset:128
    ds_read_b64_tr_b16 v[212:213], v45 offset:160
    ds_read_b64_tr_b16 v[216:217], v46 offset:128
    ds_read_b64_tr_b16 v[220:221], v46 offset:160
    ds_read_b64_tr_b16 v[224:225], v47 offset:128
    ds_read_b64_tr_b16 v[228:229], v47 offset:160
    ds_read_b64_tr_b16 v[232:233], v45 offset:192
    ds_read_b64_tr_b16 v[236:237], v45 offset:224
    ds_read_b64_tr_b16 v[240:241], v46 offset:192
    ds_read_b64_tr_b16 v[244:245], v46 offset:224
    s_waitcnt lgkmcnt(4)
    s_nop 0
    ds_read_b64_tr_b16 v[248:249], v47 offset:192
    ds_read_b64_tr_b16 v[252:253], v47 offset:224
    v_add_u32 v44, 67584, v44
    v_add_u32 v45, 67584, v45
    v_add_u32 v46, 67584, v46
    v_add_u32 v47, 67584, v47
    s_waitcnt lgkmcnt(0)
    s_setprio 2
    s_barrier
    s_nop 0
    buffer_load_dwordx4 v[16:19], v8, s[60:63], s68 offen sc1
L_PAD5:
    s_cbranch_execz L_PAD6
    s_nop 0
    buffer_load_dwordx4 v[20:23], v8, s[60:63], s20 offen sc1
    buffer_load_dwordx4 v[24:27], v8, s[60:63], s21 offen sc1
    buffer_load_dwordx4 v[28:31], v8, s[60:63], s22 offen sc1
    buffer_load_dwordx4 v[32:35], v9, s[60:63], s69 offen sc1
    buffer_load_dwordx4 v[36:39], v9, s[60:63], s23 offen sc1
    s_barrier
    s_nop 0
    ds_read_b128 v[48:51], v11 offset:0
    ds_read_b128 v[52:55], v11 offset:64
    ds_read_b128 v[56:59], v11 offset:128
    ds_read_b128 v[60:63], v11 offset:192
    ds_read_b64_tr_b16 v[130:131], v44 offset:0
    ds_read_b64_tr_b16 v[134:135], v44 offset:32
    ds_read_b64_tr_b16 v[138:139], v44 offset:64
    ds_read_b64_tr_b16 v[142:143], v44 offset:96
    ds_read_b64_tr_b16 v[146:147], v44 offset:128
    ds_read_b64_tr_b16 v[150:151], v44 offset:160
    ds_read_b64_tr_b16 v[154:155], v44 offset:192
    ds_read_b64_tr_b16 v[158:159], v44 offset:224
    ds_read_b64_tr_b16 v[162:163], v45 offset:0
    ds_read_b64_tr_b16 v[166:167], v45 offset:32
L_h1_10:
    s_waitcnt vmcnt(5) lgkmcnt(8)
    ds_write_b128 v6, v[16:19] offset:0
    v_add_u32 v13, v16, v17
    v_add3_u32 v13, v13, v18, v19
    s_waitcnt vmcnt(4)
    ds_write_b128 v6, v[20:23] offset:128
    v_add3_u32 v13, v13, v20, v21
    v_add3_u32 v13, v13, v22, v23
    s_waitcnt vmcnt(3)
    ds_write_b128 v6, v[24:27] offset:256
    v_add3_u32 v13, v13, v24, v25
    v_add3_u32 v13, v13, v26, v27
    s_waitcnt vmcnt(2)
    ds_write_b128 v6, v[28:31] offset:384
    v_add3_u32 v13, v13, v28, v29
    v_add3_u32 v13, v13, v30, v31
    s_waitcnt vmcnt(1)
    v_add3_u32 v13, v13, v32, v33
    v_add3_u32 v13, v13, v34, v35
    s_waitcnt vmcnt(0)
    v_add3_u32 v13, v13, v36, v37
    v_add3_u32 v13, v13, v38, v39
    s_nop 1
    v_add_u32_dpp v13, v13, v13 row_ror:1 row_mask:0xf bank_mask:0xf
    s_nop 1
    v_add_u32_dpp v13, v13, v13 row_ror:2 row_mask:0xf bank_mask:0xf
    s_nop 1
    v_add_u32_dpp v13, v13, v13 row_ror:4 row_mask:0xf bank_mask:0xf
    s_nop 1
    v_add_u32_dpp v13, v13, v13 row_ror:8 row_mask:0xf bank_mask:0xf
    v_cmp_ne_u32 vcc, s75, v13
    s_waitcnt lgkmcnt(0)
    s_cbranch_vccnz L_h1r_12
L_h1d_11:
    s_mov_b64 exec, -1
    s_barrier
    ds_read_b128 v[24:27], v7 offset:0
    ds_read_b128 v[28:31], v7 offset:64
    ds_read_b128 v[32:35], v7 offset:128
    ds_read_b128 v[36:39], v7 offset:192
    ds_read_b128 v[40:43], v7 offset:256
    v_lshrrev_b32 v9, 2, v0
    v_lshlrev_b32 v8, 2, v9
    v_lshlrev_b32 v9, 14, v9
    v_and_b32 v13, 3, v0
    v_lshl_add_u32 v9, v13, 4, v9
    v_lshlrev_b32_e64 v6, 7, v0
    v_lshl_add_u32 v2, v2, 4, s74
    v_bfe_u32 v13, v0, 3, 1
    v_lshl_add_u32 v2, v2, 1, v13
    v_lshlrev_b32 v2, 2, v2
    s_waitcnt lgkmcnt(4)
    v_mfma_f32_16x16x32_bf16 v[16:19], v[64:67], v[24:27], 0
    v_mfma_f32_16x16x32_bf16 v[20:23], v[48:51], v[24:27], 0
    s_waitcnt lgkmcnt(3)
    v_mfma_f32_16x16x32_bf16 v[16:19], v[68:71], v[28:31], v[16:19]
    v_mfma_f32_16x16x32_bf16 v[20:23], v[52:55], v[28:31], v[20:23]
    ds_read_b128 v[64:67], v11 offset:256
    ds_read_b128 v[24:27], v7 offset:320
    s_waitcnt lgkmcnt(4)
    v_mfma_f32_16x16x32_bf16 v[16:19], v[72:75], v[32:35], v[16:19]
    ds_read_b128 v[48:51], v11 offset:320
    v_mfma_f32_16x16x32_bf16 v[20:23], v[56:59], v[32:35], v[20:23]
    ds_read_b128 v[68:71], v7 offset:384
    ds_read_b128 v[28:31], v11 offset:384
    s_waitcnt lgkmcnt(6)
    v_mfma_f32_16x16x32_bf16 v[16:19], v[76:79], v[36:39], v[16:19]
    ds_read_b128 v[52:55], v7 offset:448
    v_mfma_f32_16x16x32_bf16 v[20:23], v[60:63], v[36:39], v[20:23]
    ds_read_b128 v[72:75], v11 offset:448
    ds_read_b128 v[32:35], v7 offset:512
    s_waitcnt lgkmcnt(7)
    v_mfma_f32_16x16x32_bf16 v[16:19], v[80:83], v[40:43], v[16:19]
    ds_read_b128 v[56:59], v11 offset:512
    v_mfma_f32_16x16x32_bf16 v[20:23], v[64:67], v[40:43], v[20:23]
    ds_read_b128 v[76:79], v7 offset:576
    ds_read_b128 v[36:39], v11 offset:576
    s_waitcnt lgkmcnt(8)
    v_mfma_f32_16x16x32_bf16 v[16:19], v[84:87], v[24:27], v[16:19]
    ds_read_b128 v[60:63], v7 offset:640
    v_mfma_f32_16x16x32_bf16 v[20:23], v[48:51], v[24:27], v[20:23]
    ds_read_b128 v[80:83], v11 offset:640
    ds_read_b128 v[40:43], v7 offset:704
    s_waitcnt lgkmcnt(9)
    v_mfma_f32_16x16x32_bf16 v[16:19], v[88:91], v[68:71], v[16:19]
    ds_read_b128 v[64:67], v11 offset:704
    v_mfma_f32_16x16x32_bf16 v[20:23], v[28:31], v[68:71], v[20:23]
    ds_read_b128 v[84:87], v7 offset:768
    ds_read_b128 v[24:27], v11 offset:768
    s_waitcnt lgkmcnt(10)
    v_mfma_f32_16x16x32_bf16 v[16:19], v[92:95], v[52:55], v[16:19]
    ds_read_b128 v[48:51], v7 offset:832
    v_mfma_f32_16x16x32_bf16 v[20:23], v[72:75], v[52:55], v[20:23]
    ds_read_b128 v[88:91], v11 offset:832
    s_waitcnt lgkmcnt(10)
    v_mfma_f32_16x16x32_bf16 v[16:19], v[96:99], v[32:35], v[16:19]
    ds_read_b128 v[68:71], v7 offset:896
    v_mfma_f32_16x16x32_bf16 v[20:23], v[56:59], v[32:35], v[20:23]
    ds_read_b128 v[28:31], v11 offset:896
    s_waitcnt lgkmcnt(10)
    v_mfma_f32_16x16x32_bf16 v[16:19], v[100:103], v[76:79], v[16:19]
    ds_read_b128 v[92:95], v7 offset:960
    v_mfma_f32_16x16x32_bf16 v[20:23], v[36:39], v[76:79], v[20:23]
    ds_read_b128 v[52:55], v11 offset:960
    s_waitcnt lgkmcnt(10)
    v_mfma_f32_16x16x32_bf16 v[16:19], v[104:107], v[60:63], v[16:19]
    ds_read_b64_tr_b16 v[170:171], v46 offset:0
    v_mfma_f32_16x16x32_bf16 v[20:23], v[80:83], v[60:63], v[20:23]
    ds_read_b64_tr_b16 v[174:175], v46 offset:32
    s_waitcnt lgkmcnt(10)
    v_mfma_f32_16x16x32_bf16 v[16:19], v[108:111], v[40:43], v[16:19]
    ds_read_b64_tr_b16 v[178:179], v47 offset:0
    v_mfma_f32_16x16x32_bf16 v[20:23], v[64:67], v[40:43], v[20:23]
    ds_read_b64_tr_b16 v[182:183], v47 offset:32
    s_waitcnt lgkmcnt(10)
    v_mfma_f32_16x16x32_bf16 v[16:19], v[112:115], v[84:87], v[16:19]
    ds_read_b64_tr_b16 v[186:187], v45 offset:64
    v_mfma_f32_16x16x32_bf16 v[20:23], v[24:27], v[84:87], v[20:23]
    ds_read_b64_tr_b16 v[190:191], v45 offset:96
    s_waitcnt lgkmcnt(10)
    v_mfma_f32_16x16x32_bf16 v[16:19], v[116:119], v[48:51], v[16:19]
    ds_read_b64_tr_b16 v[194:195], v46 offset:64
    v_mfma_f32_16x16x32_bf16 v[20:23], v[88:91], v[48:51], v[20:23]
    ds_read_b64_tr_b16 v[198:199], v46 offset:96
    s_waitcnt lgkmcnt(10)
    v_mfma_f32_16x16x32_bf16 v[16:19], v[120:123], v[68:71], v[16:19]
L_PAD6:
    s_cbranch_execz L_PAD7
    s_nop 0
    ds_read_b64_tr_b16 v[202:203], v47 offset:64
    v_mfma_f32_16x16x32_bf16 v[20:23], v[28:31], v[68:71], v[20:23]
    ds_read_b64_tr_b16 v[206:207], v47 offset:96
    s_waitcnt lgkmcnt(10)
    s_nop 0
    v_mfma_f32_16x16x32_bf16 v[16:19], v[124:127], v[92:95], v[16:19]
    ds_read_b64_tr_b16 v[210:211], v45 offset:128
    v_mfma_f32_16x16x32_bf16 v[20:23], v[52:55], v[92:95], v[20:23]
    ds_read_b64_tr_b16 v[214:215], v45 offset:160
    v_mov_b32 v60, 0x3f803f80
    v_mov_b32 v61, 0x3f803f80
    v_mov_b32 v62, 0x3f803f80
    v_mov_b32 v63, 0x3f803f80
    v_xor_b32 v52, 1024, v10
    v_xor_b32 v53, 2048, v10
    v_xor_b32 v54, 3072, v10
    v_max3_f32 v24, v16, v17, v18
    v_max3_f32 v25, v20, v21, v22
    v_max3_f32 v24, v24, v19, v23
    v_max_f32_e64 v24, v24, v25
    ds_max_f32 v1, v24 offset:27728
    s_waitcnt lgkmcnt(0)
    s_barrier
    ds_read_b32 v24, v1 offset:27728
    ds_read_b32 v56, v8 offset:27728
    ds_read_b64_tr_b16 v[218:219], v46 offset:128
    ds_read_b64_tr_b16 v[222:223], v46 offset:160
    ds_read_b64_tr_b16 v[226:227], v47 offset:128
    ds_read_b64_tr_b16 v[230:231], v47 offset:160
    ds_read_b64_tr_b16 v[234:235], v45 offset:192
    ds_read_b64_tr_b16 v[238:239], v45 offset:224
    ds_read_b64_tr_b16 v[242:243], v46 offset:192
    ds_read_b64_tr_b16 v[246:247], v46 offset:224
    ds_read_b64_tr_b16 v[250:251], v47 offset:192
    ds_read_b64_tr_b16 v[254:255], v47 offset:224
    s_waitcnt lgkmcnt(11)
    v_mul_f32 v24, s50, v24
    v_fma_f32 v16, v16, s50, -v24
    v_fma_f32 v17, v17, s50, -v24
    v_fma_f32 v18, v18, s50, -v24
    v_fma_f32 v19, v19, s50, -v24
    v_fma_f32 v20, v20, s50, -v24
    v_fma_f32 v21, v21, s50, -v24
    v_fma_f32 v22, v22, s50, -v24
    v_fma_f32 v23, v23, s50, -v24
    v_exp_f32 v16, v16
    v_exp_f32 v17, v17
    v_exp_f32 v18, v18
    v_exp_f32 v19, v19
    v_cvt_pk_bf16_f32 v64, v16, v17
    v_exp_f32 v20, v20
    v_exp_f32 v21, v21
    v_cvt_pk_bf16_f32 v65, v18, v19
    v_exp_f32 v22, v22
    v_exp_f32 v23, v23
    v_cvt_pk_bf16_f32 v66, v20, v21
    v_cvt_pk_bf16_f32 v67, v22, v23
    ds_write_b128 v10, v[64:67] offset:21120
    s_nop 0
    v_mfma_f32_16x16x32_bf16 v[80:83], v[64:67], v[128:131], 0
    v_mfma_f32_16x16x32_bf16 v[84:87], v[64:67], v[132:135], 0
    v_mfma_f32_16x16x32_bf16 v[88:91], v[64:67], v[136:139], 0
    s_waitcnt lgkmcnt(0)
    s_barrier
    s_nop 0
    ds_read_b128 v[68:71], v52 offset:21120
    ds_read_b128 v[72:75], v53 offset:21120
    ds_read_b128 v[76:79], v54 offset:21120
    v_mfma_f32_16x16x32_bf16 v[92:95], v[64:67], v[140:143], 0
    v_mfma_f32_16x16x32_bf16 v[96:99], v[64:67], v[144:147], 0
    v_mfma_f32_16x16x32_bf16 v[100:103], v[64:67], v[148:151], 0
    v_mfma_f32_16x16x32_bf16 v[104:107], v[64:67], v[152:155], 0
    v_mfma_f32_16x16x32_bf16 v[108:111], v[64:67], v[156:159], 0
    v_mul_f32_e64 v56, s50, v56
    v_mfma_f32_16x16x32_bf16 v[24:27], v[64:67], v[60:63], 0
    s_waitcnt lgkmcnt(2)
    v_mfma_f32_16x16x32_bf16 v[80:83], v[68:71], v[160:163], v[80:83]
    v_mfma_f32_16x16x32_bf16 v[84:87], v[68:71], v[164:167], v[84:87]
    s_waitcnt lgkmcnt(1)
    v_mfma_f32_16x16x32_bf16 v[80:83], v[72:75], v[168:171], v[80:83]
    v_mfma_f32_16x16x32_bf16 v[84:87], v[72:75], v[172:175], v[84:87]
    s_waitcnt lgkmcnt(0)
    s_nop 0
    v_mfma_f32_16x16x32_bf16 v[80:83], v[76:79], v[176:179], v[80:83]
    v_mfma_f32_16x16x32_bf16 v[84:87], v[76:79], v[180:183], v[84:87]
    v_mfma_f32_16x16x32_bf16 v[88:91], v[68:71], v[184:187], v[88:91]
    v_mfma_f32_16x16x32_bf16 v[92:95], v[68:71], v[188:191], v[92:95]
    v_mfma_f32_16x16x32_bf16 v[88:91], v[72:75], v[192:195], v[88:91]
    v_mfma_f32_16x16x32_bf16 v[92:95], v[72:75], v[196:199], v[92:95]
    v_mfma_f32_16x16x32_bf16 v[88:91], v[76:79], v[200:203], v[88:91]
    v_mfma_f32_16x16x32_bf16 v[92:95], v[76:79], v[204:207], v[92:95]
    v_mfma_f32_16x16x32_bf16 v[96:99], v[68:71], v[208:211], v[96:99]
    v_mfma_f32_16x16x32_bf16 v[100:103], v[68:71], v[212:215], v[100:103]
    v_cvt_pk_bf16_f32 v32, v80, v84
    v_mfma_f32_16x16x32_bf16 v[96:99], v[72:75], v[216:219], v[96:99]
    v_cvt_pk_bf16_f32 v36, v81, v85
    v_mfma_f32_16x16x32_bf16 v[100:103], v[72:75], v[220:223], v[100:103]
    v_cvt_pk_bf16_f32 v40, v82, v86
    v_mfma_f32_16x16x32_bf16 v[96:99], v[76:79], v[224:227], v[96:99]
    v_cvt_pk_bf16_f32 v44, v83, v87
    v_mfma_f32_16x16x32_bf16 v[100:103], v[76:79], v[228:231], v[100:103]
    v_cvt_pk_bf16_f32 v33, v88, v92
    v_mfma_f32_16x16x32_bf16 v[104:107], v[68:71], v[232:235], v[104:107]
    v_cvt_pk_bf16_f32 v37, v89, v93
    v_mfma_f32_16x16x32_bf16 v[108:111], v[68:71], v[236:239], v[108:111]
    v_cvt_pk_bf16_f32 v41, v90, v94
    v_mfma_f32_16x16x32_bf16 v[104:107], v[72:75], v[240:243], v[104:107]
    v_cvt_pk_bf16_f32 v45, v91, v95
    v_mfma_f32_16x16x32_bf16 v[108:111], v[72:75], v[244:247], v[108:111]
    v_mfma_f32_16x16x32_bf16 v[104:107], v[76:79], v[248:251], v[104:107]
    v_cvt_pk_bf16_f32 v34, v96, v100
    v_mfma_f32_16x16x32_bf16 v[108:111], v[76:79], v[252:255], v[108:111]
    v_cvt_pk_bf16_f32 v38, v97, v101
    v_mfma_f32_16x16x32_bf16 v[24:27], v[68:71], v[60:63], v[24:27]
    v_cvt_pk_bf16_f32 v42, v98, v102
    v_mfma_f32_16x16x32_bf16 v[24:27], v[72:75], v[60:63], v[24:27]
    v_cvt_pk_bf16_f32 v46, v99, v103
    v_mfma_f32_16x16x32_bf16 v[24:27], v[76:79], v[60:63], v[24:27]
    v_add3_u32 v48, v32, v33, v34
    v_add3_u32 v49, v36, v37, v38
    v_add3_u32 v50, v40, v41, v42
    v_add3_u32 v51, v44, v45, v46
    v_cvt_pk_bf16_f32 v35, v104, v108
    buffer_store_dwordx4 v[32:35], v14, s[60:63], s6 offen sc1
    v_cvt_pk_bf16_f32 v39, v105, v109
    buffer_store_dwordx4 v[36:39], v14, s[60:63], s16 offen sc1
    v_cvt_pk_bf16_f32 v43, v106, v110
    buffer_store_dwordx4 v[40:43], v14, s[60:63], s17 offen sc1
    v_cvt_pk_bf16_f32 v47, v107, v111
    buffer_store_dwordx4 v[44:47], v14, s[60:63], s18 offen sc1
    v_add_u32 v48, v48, v35
    v_add_u32 v49, v49, v39
    v_add_u32 v50, v50, v43
    v_add_u32 v51, v51, v47
    v_add_u32_dpp v48, v48, v48 quad_perm:[1,0,3,2] row_mask:0xf bank_mask:0xf
    v_add_u32_dpp v49, v49, v49 quad_perm:[1,0,3,2] row_mask:0xf bank_mask:0xf
    v_add_u32_dpp v50, v50, v50 quad_perm:[1,0,3,2] row_mask:0xf bank_mask:0xf
    v_add_u32_dpp v51, v51, v51 quad_perm:[1,0,3,2] row_mask:0xf bank_mask:0xf
    v_add_u32_dpp v48, v48, v48 quad_perm:[2,3,0,1] row_mask:0xf bank_mask:0xf
    v_add_u32_dpp v49, v49, v49 quad_perm:[2,3,0,1] row_mask:0xf bank_mask:0xf
L_PAD7:
    s_cbranch_execz L_PAD8
    s_nop 0
    v_add_u32_dpp v50, v50, v50 quad_perm:[2,3,0,1] row_mask:0xf bank_mask:0xf
    v_add_u32_dpp v51, v51, v51 quad_perm:[2,3,0,1] row_mask:0xf bank_mask:0xf
    v_add_u32_dpp v48, v48, v48 row_half_mirror row_mask:0xf bank_mask:0xf
    v_add_u32_dpp v49, v49, v49 row_half_mirror row_mask:0xf bank_mask:0xf
    v_add_u32_dpp v50, v50, v50 row_half_mirror row_mask:0xf bank_mask:0xf
    v_add_u32_dpp v51, v51, v51 row_half_mirror row_mask:0xf bank_mask:0xf
    ds_write_b32 v2, v48 offset:27792
    ds_write_b32 v2, v49 offset:27824
    ds_write_b32 v2, v50 offset:27856
    ds_write_b32 v2, v51 offset:27888
    v_lshlrev_b32 v7, 3, v0
    s_mov_b64 exec, 1
    ds_add_rtn_u32 v13, v15, v12 offset:16
    s_mov_b64 exec, -1
    ds_read_b64 v[58:59], v7 offset:27792
    v_mov_b32_dpp v57, v24 quad_perm:[0,1,2,3] row_mask:0xf bank_mask:1
    s_nop 1
    v_mov_b32_dpp v57, v25 quad_perm:[0,1,2,3] row_mask:0xf bank_mask:2
    s_nop 1
    v_mov_b32_dpp v57, v26 quad_perm:[0,1,2,3] row_mask:0xf bank_mask:4
    s_nop 1
    v_mov_b32_dpp v57, v27 quad_perm:[0,1,2,3] row_mask:0xf bank_mask:8
    v_sub_u32 v48, s46, v56
    v_sub_u32 v48, v48, v57
    s_waitcnt lgkmcnt(0)
    v_readfirstlane_b32 s70, v13
    v_sub_u32 v58, v48, v58
    v_sub_u32 v59, v48, v59
    s_cmp_lg_u32 s70, 3
    s_cbranch_scc1 L_nl_13
    buffer_store_dwordx4 v[56:59], v9, s[60:63], s7 offen sc1
    s_mov_b64 exec, 0xffff
    buffer_atomic_add v12, v6, s[60:63], s12 offen
    s_mov_b64 exec, 1
    ds_add_u32 v15, v12 offset:16
    s_mov_b64 exec, -1
L_nl_13:
    s_mul_i32 s70, s74, 144
    s_add_u32 s70, s70, 26944
    v_add_u32 v8, s70, v5
    v_lshrrev_b32 v2, 4, v0
    v_bfe_u32 v6, v0, 2, 2
    v_and_b32_e64 v7, 3, v0
    v_mul_u32_u24 v44, 2176, v2
    v_lshl_add_u32 v44, v6, 8, v44
    v_lshl_add_u32 v44, v7, 3, v44
    s_lshl_b32 s70, s74, 1
    v_xor_b32 v9, s70, v6
    v_xor_b32_e64 v10, 1, v9
    v_lshl_add_u32 v45, v10, 5, v44
    v_lshl_add_u32 v44, v9, 5, v44
    v_mul_u32_u24 v46, 1088, v2
    v_lshl_add_u32 v46, v6, 7, v46
    v_lshl_add_u32 v46, v7, 3, v46
    v_lshrrev_b32 v9, 1, v6
    v_xor_b32 v9, s74, v9
    v_lshl_add_u32 v46, v9, 5, v46
    v_cmp_eq_u32 vcc, 0, v6
    s_nop 1
    v_cndmask_b32 v47, 4, v7, vcc
    v_cmp_eq_u32 vcc, 1, v6
    s_nop 1
    v_cndmask_b32 v48, 4, v7, vcc
    v_mul_u32_u24 v47, 144, v47
    v_mul_u32_u24 v48, 144, v48
    v_lshl_add_u32 v47, v2, 4, v47
    v_lshl_add_u32 v48, v2, 4, v48
    v_lshlrev_b32_e64 v49, 9, v7
    v_lshl_add_u32 v49, v6, 6, v49
    v_lshl_add_u32 v49, v2, 4, v49
    v_mul_u32_u24 v50, 288, v7
    v_lshl_add_u32 v50, v2, 4, v50
    ds_read_b32 v51, v15 offset:8
    s_lshl3_add_u32 s6, s36, s37
    s_lshl_b32 s6, s6, 11
    s_lshl_b32 s70, s74, 7
    s_add_u32 s6, s6, s70
    s_add_u32 s6, s6, 266240
    s_lshl_b32 s68, s36, 14
    s_lshl_b32 s70, s74, 9
    s_add_u32 s68, s68, s70
    s_add_u32 s68, s68, 266240
    v_lshlrev_b32 v53, 2, v1
    v_lshl_add_u32 v52, v2, 12, v53
    s_lshl_b32 s70, s74, 8
    v_add_u32 v53, s70, v53
    v_lshlrev_b32_e64 v9, 1, v1
    v_bfe_u32 v6, v0, 4, 1
    v_lshl_add_u32 v9, v6, 2, v9
    v_lshrrev_b32_e64 v6, 5, v0
    v_lshl_add_u32 v9, v6, 7, v9
    s_mul_i32 s70, s74, 288
    v_add_u32_e64 v9, s70, v9
    s_mul_i32 s16, s37, 2688
    s_add_u32 s16, s16, 1052672
    s_lshl_b32 s70, s74, 7
    s_add_u32 s17, s16, s70
    s_lshl_b32 s70, s74, 9
    s_add_u32 s16, s16, s70
    s_lshl2_add_u32 s5, s37, s74
    s_lshl_b32 s5, s5, 5
    s_mov_b32 s20, 0x80008000
    s_mov_b32 s21, s20
    s_mov_b64 s[22:23], 0x1111
    v_lshl_add_u32 v42, v2, 7, v1
    v_mov_b32 v7, 0x10000
    v_lshrrev_b32 v54, 1, v1
    v_lshl_add_u32 v54, v2, 10, v54
    v_cndmask_b32 v54, v54, v7, s[20:21]
    v_lshl_add_u32 v55, v1, 6, 30
    v_cndmask_b32 v55, v7, v55, s[22:23]
    v_mov_b32 v43, 0x41f80000
    s_mov_b64 s[64:65], s[28:29]
    s_mov_b32 s66, 4096
    s_mov_b32 s67, 0x20000
    v_mov_b32 v10, s48
    v_mov_b32_e64 v11, s49
    v_cndmask_b32 v10, v10, v11, s[26:27]
    s_lshl_b32 s75, s46, 3
    s_mov_b32 s72, 40
    s_waitcnt vmcnt(1)
L_pp_14:
    s_mov_b32 s4, 0
    s_atomic_add s4, s[32:33], s13 glc
    s_sub_u32 s72, s72, 1
    s_cselect_b32 s15, 32, 0
    s_waitcnt lgkmcnt(0)
    s_sub_u32 s4, s4, s14
    s_or_b32 s4, s4, s15
    s_cmp_lt_u32 s4, 32
    s_cbranch_scc1 L_pp_14
    s_nop 0
    buffer_load_dwordx4 v[80:83], v4, s[60:63], s9 offen offset:0 sc1
    buffer_load_dwordx4 v[84:87], v4, s[60:63], s9 offen offset:256 sc1
    buffer_load_dwordx4 v[88:91], v3, s[60:63], s8 offen offset:0 sc1
    buffer_load_dwordx4 v[92:95], v3, s[60:63], s8 offen offset:256 sc1
    buffer_load_dwordx4 v[96:99], v3, s[60:63], s8 offen offset:512 sc1
    buffer_load_dwordx4 v[100:103], v3, s[60:63], s8 offen offset:768 sc1
    s_mov_b64 exec, 1
    ds_add_u32 v15, v12 offset:12
    s_mov_b64 exec, -1
    v_readfirstlane_b32 s50, v51
    v_mov_b32 v11, s45
L_fw_15:
    ds_read_b32 v13, v15 offset:24
    s_waitcnt lgkmcnt(0)
    v_cmp_gt_u32 vcc, 1, v13
    s_nop 0
    s_cbranch_vccnz L_fw_15
    ds_read_b64_tr_b16 v[184:185], v44 offset:28416
    ds_read_b64_tr_b16 v[186:187], v44 offset:29504
    ds_read_b64_tr_b16 v[188:189], v44 offset:37120
    ds_read_b64_tr_b16 v[190:191], v44 offset:38208
    ds_read_b64_tr_b16 v[192:193], v45 offset:28416
    ds_read_b64_tr_b16 v[194:195], v45 offset:29504
    ds_read_b64_tr_b16 v[196:197], v45 offset:37120
    ds_read_b64_tr_b16 v[198:199], v45 offset:38208
    s_mov_b32 s72, 65536
L_h2_16:
    s_waitcnt vmcnt(4)
    v_max_f32 v16, v80, v84
    v_cndmask_b32 v26, v82, v83, s[24:25]
    v_cndmask_b32 v27, v86, v87, s[24:25]
    v_max_f32_dpp v16, v16, v16 row_ror:4 row_mask:0xf bank_mask:0xf
    v_add3_u32 v13, v80, v81, v26
    v_add3_u32 v13, v13, v84, v85
L_PAD8:
    s_cbranch_execz L_PAD9
    s_nop 0
    v_max_f32_dpp v16, v16, v16 row_ror:8 row_mask:0xf bank_mask:0xf
    v_add_u32_e64 v13, v13, v27
    v_cndmask_b32 v13, 0, v13, s[10:11]
    v_max_f32_dpp v16, v16, v16 row_bcast:15 row_mask:0xa bank_mask:0xf
    s_waitcnt vmcnt(2)
    s_nop 0
    v_perm_b32 v120, v92, v88, s48
    v_max_f32_dpp v16, v16, v16 row_bcast:31 row_mask:0xc bank_mask:0xf
    v_perm_b32 v122, v92, v88, s49
    v_readlane_b32 s70, v16, 63
    v_perm_b32 v124, v93, v89, s48
    v_perm_b32 v126, v93, v89, s49
    v_subrev_f32 v16, s70, v80
    v_subrev_f32 v17, s70, v84
    v_exp_f32 v16, v16
    v_exp_f32 v17, v17
    v_perm_b32 v128, v94, v90, s48
    v_cvt_pk_bf16_f32 v18, v16, v17
    v_perm_b32 v130, v94, v90, s49
    v_perm_b32 v132, v95, v91, s48
    v_mov_b32_dpp v19, v18 row_shl:4 row_mask:0xf bank_mask:0x5
    v_perm_b32 v20, v19, v18, v10
    v_perm_b32 v134, v95, v91, s49
    s_waitcnt vmcnt(0)
    s_nop 0
    v_mov_b32_dpp v21, v20 row_shl:8 row_mask:0xf bank_mask:0x1
    v_perm_b32 v121, v100, v96, s48
    v_perm_b32 v123, v100, v96, s49
    v_perm_b32 v125, v101, v97, s48
    v_perm_b32 v127, v101, v97, s49
    v_perm_b32 v129, v102, v98, s48
    v_perm_b32 v131, v102, v98, s49
    v_perm_b32 v133, v103, v99, s48
    v_perm_b32 v135, v103, v99, s49
    v_mfma_f32_16x16x16_bf16 v[152:155], v[20:21], v[120:121], 0
    v_add3_u32 v13, v13, v88, v89
    v_add3_u32 v13, v13, v90, v91
    v_mfma_f32_16x16x16_bf16 v[156:159], v[20:21], v[122:123], 0
    v_add3_u32 v13, v13, v92, v93
    v_add3_u32 v13, v13, v94, v95
    v_mfma_f32_16x16x16_bf16 v[160:163], v[20:21], v[124:125], 0
    v_add3_u32 v13, v13, v96, v97
    v_add3_u32 v13, v13, v98, v99
    v_mfma_f32_16x16x16_bf16 v[164:167], v[20:21], v[126:127], 0
    v_add3_u32 v13, v13, v100, v101
    v_add3_u32 v13, v13, v102, v103
    v_mfma_f32_16x16x16_bf16 v[168:171], v[20:21], v[128:129], 0
    v_add_f32_dpp v24, v153, v152 row_ror:8 row_mask:0xf bank_mask:0xf
    v_add_u32_dpp v13, v13, v13 row_ror:1 row_mask:0xf bank_mask:0xf
    v_mfma_f32_16x16x16_bf16 v[172:175], v[20:21], v[130:131], 0
    v_add_f32_dpp v25, v157, v156 row_ror:8 row_mask:0xf bank_mask:0xf
    v_add_u32_dpp v13, v13, v13 row_ror:2 row_mask:0xf bank_mask:0xf
    v_mfma_f32_16x16x16_bf16 v[176:179], v[20:21], v[132:133], 0
    v_add_f32_dpp v26, v161, v160 row_ror:8 row_mask:0xf bank_mask:0xf
    v_add_u32_dpp v13, v13, v13 row_ror:4 row_mask:0xf bank_mask:0xf
    v_mfma_f32_16x16x16_bf16 v[180:183], v[20:21], v[134:135], 0
    v_add_f32_dpp v27, v165, v164 row_ror:8 row_mask:0xf bank_mask:0xf
    v_add_u32_dpp v13, v13, v13 row_ror:8 row_mask:0xf bank_mask:0xf
    v_add_f32_dpp v28, v169, v168 row_ror:8 row_mask:0xf bank_mask:0xf
    v_cmp_ne_u32_e64 vcc, s75, v13
    v_add_f32_dpp v29, v173, v172 row_ror:8 row_mask:0xf bank_mask:0xf
    v_cvt_pk_bf16_f32 v32, v24, v25
    v_cvt_pk_bf16_f32 v33, v26, v27
    v_add_f32_dpp v30, v177, v176 row_ror:8 row_mask:0xf bank_mask:0xf
    v_cvt_pk_bf16_f32 v34, v28, v29
    v_add_f32_dpp v31, v181, v180 row_ror:8 row_mask:0xf bank_mask:0xf
    v_cvt_pk_bf16_f32 v35, v30, v31
    s_nop 0
    s_cbranch_vccnz L_h2r_17
L_h2d_18:
    s_mov_b64 exec, 0xff
    ds_write_b128 v8, v[32:35]
    s_mov_b64 exec, 1
    ds_add_u32 v15, v12 offset:20
    s_mov_b64 exec, -1
    s_cmp_eq_u32 s50, 1
L_cw_19:
    ds_read_b32 v13, v15 offset:20
    ds_read_b128 v[200:203], v47 offset:26944
    ds_read_b128 v[204:207], v47 offset:27008
    ds_read_b128 v[208:211], v48 offset:26944
    ds_read_b128 v[212:215], v48 offset:27008
    s_waitcnt lgkmcnt(4)
    v_cmp_gt_u32_e64 vcc, 4, v13
    s_waitcnt lgkmcnt(0)
    s_cbranch_vccnz L_cw_19
    v_mfma_f32_16x16x32_bf16 v[216:219], v[184:187], v[200:203], 0
    v_mfma_f32_16x16x32_bf16 v[216:219], v[188:191], v[204:207], v[216:219]
    v_mfma_f32_16x16x32_bf16 v[216:219], v[192:195], v[208:211], v[216:219]
    v_mfma_f32_16x16x32_bf16 v[216:219], v[196:199], v[212:215], v[216:219]
    v_lshlrev_b32_e64 v16, 16, v18
    v_and_b32 v17, 0xffff0000, v18
    v_mul_f32 v16, v16, v81
    v_fmac_f32 v16, v17, v85
    v_mov_b32_e64 v40, v16
    s_mov_b32 s72, 65536
    s_mov_b32 exec_lo, 0x00ff00ff
    s_mov_b32 exec_hi, 0x00ff00ff
    v_and_or_b32 v216, v216, s47, v11
    v_and_or_b32 v217, v217, s47, v11
    v_and_or_b32 v218, v218, s47, v11
    v_and_or_b32 v219, v219, s47, v11
    s_nop 0
    s_cbranch_scc0 L_pl_20
    buffer_store_dwordx4 v[216:219], v49, s[60:63], s6 offen
L_pl_21:
    s_mov_b64 exec, 1
    ds_add_u32 v15, v12 offset:28
    s_mov_b64 exec, -1
L_fw_23:
    ds_read_b32 v13, v15 offset:28
    s_waitcnt lgkmcnt(0)
    v_cmp_gt_u32 vcc, 5, v13
    s_nop 0
    s_cbranch_vccnz L_fw_23
    buffer_load_dwordx4 v[16:19], v52, s[60:63], s68 offen offset:0 sc1
    buffer_load_dwordx4 v[20:23], v52, s[60:63], s68 offen offset:256 sc1
    buffer_load_dwordx4 v[24:27], v52, s[60:63], s68 offen offset:2048 sc1
    buffer_load_dwordx4 v[28:31], v52, s[60:63], s68 offen offset:2304 sc1
    v_add_f32_dpp v40, v40, v40 row_ror:4 row_mask:0xf bank_mask:0xf
    s_nop 1
    v_add_f32_dpp v40, v40, v40 row_ror:8 row_mask:0xf bank_mask:0xf
    s_nop 1
    v_add_f32_dpp v40, v40, v40 row_bcast:15 row_mask:0xa bank_mask:0xf
    s_nop 1
    v_add_f32_dpp v40, v40, v40 row_bcast:31 row_mask:0xc bank_mask:0xf
    s_nop 0
    v_readlane_b32 s70, v40, 63
    s_nop 1
    v_rcp_f32 v40, s70
    ds_read_b64_tr_b16 v[184:185], v46 offset:45824
    ds_read_b64_tr_b16 v[186:187], v46 offset:46336
    ds_read_b64_tr_b16 v[188:189], v46 offset:50176
    ds_read_b64_tr_b16 v[190:191], v46 offset:50688
    ds_read_b64_tr_b16 v[192:193], v46 offset:54528
    ds_read_b64_tr_b16 v[194:195], v46 offset:55040
    ds_read_b64_tr_b16 v[196:197], v46 offset:58880
    ds_read_b64_tr_b16 v[198:199], v46 offset:59392
L_cx_22:
    s_sub_u32 s72, s72, 1
    s_cselect_b32 s7, 0, 0xff
    s_waitcnt vmcnt(3)
    v_xor_b32 v16, v16, v11
    v_xor_b32 v17, v17, v11
    v_xor_b32 v18, v18, v11
    v_xor_b32 v19, v19, v11
    v_or_b32_e64 v13, v16, v17
    v_or3_b32 v13, v13, v18, v19
    s_waitcnt vmcnt(2)
    v_xor_b32 v20, v20, v11
    v_xor_b32 v21, v21, v11
    v_xor_b32 v22, v22, v11
    v_xor_b32_e64 v23, v23, v11
L_PAD9:
    s_cbranch_execz L_BACK_T
    s_nop 0
    v_or3_b32 v13, v13, v20, v21
    v_or3_b32 v13, v13, v22, v23
    s_waitcnt vmcnt(1)
    v_xor_b32 v24, v24, v11
    v_xor_b32 v25, v25, v11
    v_xor_b32 v26, v26, v11
    v_xor_b32_e64 v27, v27, v11
    v_or3_b32 v13, v13, v24, v25
    v_or3_b32 v13, v13, v26, v27
    v_pk_add_f32 v[16:17], v[16:17], v[24:25]
    v_pk_add_f32 v[18:19], v[18:19], v[26:27]
    s_waitcnt vmcnt(0)
    v_xor_b32 v28, v28, v11
    v_xor_b32 v29, v29, v11
    v_xor_b32 v30, v30, v11
    v_xor_b32_e64 v31, v31, v11
    v_or3_b32 v13, v13, v28, v29
    v_or3_b32 v13, v13, v30, v31
    v_pk_add_f32 v[20:21], v[20:21], v[28:29]
    v_and_b32_e64 v13, s7, v13
    v_pk_add_f32 v[22:23], v[22:23], v[30:31]
    v_cmp_ne_u32_e64 vcc, 0, v13
    v_permlane32_swap_b32 v16, v20
    v_permlane32_swap_b32 v17, v21
    v_permlane32_swap_b32 v18, v22
    v_permlane32_swap_b32 v19, v23
    v_pk_add_f32 v[16:17], v[16:17], v[20:21]
    v_pk_add_f32 v[18:19], v[18:19], v[22:23]
    s_nop 0
    s_cbranch_vccnz L_cx_22_r
    v_permlane16_swap_b32 v16, v18
    v_permlane16_swap_b32 v17, v19
    v_pk_add_f32 v[16:17], v[16:17], v[18:19]
    v_pk_mul_f32 v[16:17], v[16:17], v[40:41] op_sel_hi:[1,0]
    v_cvt_pk_bf16_f32 v16, v16, v17
    ds_write_b32 v9, v16 offset:25216
    s_mov_b64 exec, 1
    ds_add_u32 v15, v12 offset:32
    s_mov_b64 exec, -1
L_cw_24:
    ds_read_b32 v13, v15 offset:32
    ds_read_b128 v[200:203], v50 offset:25216
    ds_read_b128 v[204:207], v50 offset:25280
    ds_read_b128 v[208:211], v50 offset:25344
    ds_read_b128 v[212:215], v50 offset:25408
    ds_read_b128 v[216:219], v53 offset:16896
    s_waitcnt lgkmcnt(5)
    v_cmp_gt_u32 vcc, 5, v13
    s_waitcnt lgkmcnt(0)
    s_cbranch_vccnz L_cw_24
    v_mfma_f32_16x16x32_bf16 v[216:219], v[200:203], v[184:187], v[216:219]
    v_mfma_f32_16x16x32_bf16 v[216:219], v[204:207], v[188:191], v[216:219]
    v_mfma_f32_16x16x32_bf16 v[216:219], v[208:211], v[192:195], v[216:219]
    v_mfma_f32_16x16x32_bf16 v[216:219], v[212:215], v[196:199], v[216:219]
    s_nop 7
    v_mov_b32_dpp v21, v216 row_newbcast:15 row_mask:0xf bank_mask:1
    v_mov_b32_dpp v20, v216 quad_perm:[0,1,2,3] row_mask:1 bank_mask:0xf
    s_nop 0
    v_mov_b32_dpp v21, v217 row_newbcast:15 row_mask:0xf bank_mask:2
    v_mov_b32_dpp v20, v217 quad_perm:[0,1,2,3] row_mask:2 bank_mask:0xf
    s_nop 0
    v_mov_b32_dpp v21, v218 row_newbcast:15 row_mask:0xf bank_mask:4
    v_mov_b32_dpp v20, v218 quad_perm:[0,1,2,3] row_mask:4 bank_mask:0xf
    s_nop 0
    v_mov_b32_dpp v21, v219 row_newbcast:15 row_mask:0xf bank_mask:8
    v_mov_b32_dpp v20, v219 quad_perm:[0,1,2,3] row_mask:8 bank_mask:0xf
    v_cndmask_b32 v23, v21, 1.0, s[20:21]
    v_cndmask_b32 v22, v20, 1.0, s[20:21]
    buffer_atomic_add_f32 v22, v42, s[60:63], s16 offen sc0
    s_mov_b64 exec, 0xffff
    buffer_atomic_add_f32 v23, v42, s[60:63], s17 offen offset:2048 sc0
    s_mov_b64 exec, -1
    s_waitcnt vmcnt(1)
    v_xor_b32_dpp v13, v22, v43 row_newbcast:15 row_mask:0xf bank_mask:0xf
    v_add_f32 v22, v22, v20
    v_or_b32 v24, v13, v54
    v_cvt_pk_bf16_f32 v22, v22, v22
    s_waitcnt vmcnt(0)
    v_xor_b32_dpp v13, v23, v43 row_newbcast:15 row_mask:0xf bank_mask:0xf
    v_add_f32 v23, v23, v21
    v_or_b32_e64 v25, v13, v55
    v_cvt_pk_bf16_f32 v23, v23, v23
    buffer_store_short v22, v24, s[64:67], s5 offen
    buffer_store_short v23, v25, s[64:67], s5 offen
    v_readfirstlane_b32 s70, v13
    s_nop 0
    s_or_b32 s70, s70, s5
    s_cbranch_scc1 L_TDONE
    s_mov_b64 exec, 1
    v_mov_b32 v13, s44
    buffer_store_dword v13, v5, s[60:63], 0 offen
L_TDONE:
    s_endpgm
L_h1r_12:
    s_mov_b64 exec, vcc
    s_sub_u32 s72, s72, 1
    s_cbranch_scc1 L_h1d_11
    buffer_load_dwordx4 v[16:19], v8, s[60:63], s68 offen sc1
    buffer_load_dwordx4 v[20:23], v8, s[60:63], s20 offen sc1
    buffer_load_dwordx4 v[24:27], v8, s[60:63], s21 offen sc1
    buffer_load_dwordx4 v[28:31], v8, s[60:63], s22 offen sc1
    buffer_load_dwordx4 v[32:35], v9, s[60:63], s69 offen sc1
    buffer_load_dwordx4 v[36:39], v9, s[60:63], s23 offen sc1
    s_branch L_h1_10
L_h2r_17:
    s_sub_u32 s72, s72, 1
    s_cbranch_scc1 L_h2d_18
    s_mov_b64 exec, vcc
    buffer_load_dwordx4 v[80:83], v4, s[60:63], s9 offen offset:0 sc1
    buffer_load_dwordx4 v[84:87], v4, s[60:63], s9 offen offset:256 sc1
    buffer_load_dwordx4 v[88:91], v3, s[60:63], s8 offen offset:0 sc1
    buffer_load_dwordx4 v[92:95], v3, s[60:63], s8 offen offset:256 sc1
    buffer_load_dwordx4 v[96:99], v3, s[60:63], s8 offen offset:512 sc1
    buffer_load_dwordx4 v[100:103], v3, s[60:63], s8 offen offset:768 sc1
    s_mov_b64 exec, -1
    s_branch L_h2_16
L_pl_20:
    buffer_store_dwordx4 v[216:219], v49, s[60:63], s6 offen sc1
    s_nop 0
    s_branch L_pl_21
L_cx_22_r:
    buffer_load_dwordx4 v[16:19], v52, s[60:63], s68 offen offset:0 sc1
    buffer_load_dwordx4 v[20:23], v52, s[60:63], s68 offen offset:256 sc1
    buffer_load_dwordx4 v[24:27], v52, s[60:63], s68 offen offset:2048 sc1
    buffer_load_dwordx4 v[28:31], v52, s[60:63], s68 offen offset:2304 sc1
    s_branch L_cx_22
L_WL:
    s_lshl_b32 s68, s40, 22
    s_lshl_b32 s70, s41, 17
    s_add_u32 s68, s68, s70
    s_lshl_b32 s69, s37, 19
    s_lshl_b32 s70, s36, 8
    s_add_u32 s69, s69, s70
    v_lshlrev_b32 v6, 13, v2
    v_lshl_add_u32 v6, v1, 4, v6
    v_mov_b32 v14, 1
    s_mov_b32 m0, 0
    s_mov_b32 s73, 1056
    s_mov_b32 s71, 32768
    s_mov_b64 s[52:53], s[10:11]
    s_mov_b32 s54, 16777216
    s_mov_b32 s55, 0x20000
    s_mov_b64 s[56:57], s[14:15]
    s_mov_b32 s58, 4194304
    s_mov_b32 s59, 0x20000
    s_mov_b64 s[60:61], s[32:33]
    s_mov_b32 s62, 9179136
    s_mov_b32 s63, 0x20000
    s_setprio 3
    s_barrier
    buffer_load_dwordx4 v6, s[56:59], s69 offen nt lds
    s_add_u32 m0, m0, s73
    s_add_u32 s69, s69, s71
    buffer_load_dwordx4 v6, s[56:59], s69 offen nt lds
    s_add_u32 m0, m0, s73
    s_add_u32 s69, s69, s71
    buffer_load_dwordx4 v6, s[56:59], s69 offen nt lds
    s_add_u32 m0, m0, s73
    s_add_u32 s69, s69, s71
    buffer_load_dwordx4 v6, s[56:59], s69 offen nt lds
    s_add_u32 m0, m0, s73
    s_add_u32 s69, s69, s71
    buffer_load_dwordx4 v6, s[56:59], s69 offen nt lds
    s_add_u32 m0, m0, s73
    s_add_u32 s69, s69, s71
    buffer_load_dwordx4 v6, s[56:59], s69 offen nt lds
    s_add_u32 m0, m0, s73
    s_add_u32 s69, s69, s71
    buffer_load_dwordx4 v6, s[56:59], s69 offen nt lds
    s_add_u32 m0, m0, s73
    s_add_u32 s69, s69, s71
    buffer_load_dwordx4 v6, s[56:59], s69 offen nt lds
    s_add_u32 m0, m0, s73
    s_add_u32 s69, s69, s71
    buffer_load_dwordx4 v6, s[56:59], s69 offen nt lds
L_PAD10:
    s_cbranch_execz L_PAD11
    s_nop 0
    s_add_u32 m0, m0, s73
    s_add_u32 s69, s69, s71
    buffer_load_dwordx4 v6, s[56:59], s69 offen nt lds
    s_add_u32 m0, m0, s73
    s_add_u32 s69, s69, s71
    buffer_load_dwordx4 v6, s[56:59], s69 offen nt lds
    s_add_u32 m0, m0, s73
    s_add_u32 s69, s69, s71
    buffer_load_dwordx4 v6, s[56:59], s69 offen nt lds
    s_add_u32 m0, m0, s73
    s_add_u32 s69, s69, s71
    buffer_load_dwordx4 v6, s[56:59], s69 offen nt lds
    s_add_u32 m0, m0, s73
    s_add_u32 s69, s69, s71
    buffer_load_dwordx4 v6, s[56:59], s69 offen nt lds
    s_add_u32 m0, m0, s73
    s_add_u32 s69, s69, s71
    buffer_load_dwordx4 v6, s[56:59], s69 offen nt lds
    s_add_u32 m0, m0, s73
    s_add_u32 s69, s69, s71
    buffer_load_dwordx4 v6, s[56:59], s69 offen nt lds
    s_mov_b32 m0, 28416
    s_mov_b32 s73, 4128
    s_mov_b32 s71, 4096
    s_mov_b32 s72, 2
L_ck_25:
    buffer_load_dwordx4 v5, s[52:55], s68 offen offset:0 nt lds
    s_add_u32 m0, m0, 32
    s_nop 0
    buffer_load_dwordx4 v5, s[52:55], s68 offen offset:1024 nt lds
    s_add_u32 m0, m0, 32
    s_nop 0
    buffer_load_dwordx4 v5, s[52:55], s68 offen offset:2048 nt lds
    s_add_u32 m0, m0, 32
    s_nop 0
    buffer_load_dwordx4 v5, s[52:55], s68 offen offset:3072 nt lds
    s_add_u32 m0, m0, s73
    s_add_u32 s68, s68, s71
    s_sub_u32 s72, s72, 1
    s_cbranch_scc0 L_ck_25
    s_waitcnt vmcnt(20)
    s_mov_b32 s72, 2
L_ck_26:
    buffer_load_dwordx4 v5, s[52:55], s68 offen offset:0 nt lds
    s_add_u32 m0, m0, 32
    s_nop 0
    buffer_load_dwordx4 v5, s[52:55], s68 offen offset:1024 nt lds
    s_add_u32 m0, m0, 32
    s_nop 0
    buffer_load_dwordx4 v5, s[52:55], s68 offen offset:2048 nt lds
    s_add_u32 m0, m0, 32
    s_nop 0
    buffer_load_dwordx4 v5, s[52:55], s68 offen offset:3072 nt lds
    s_add_u32 m0, m0, s73
    s_add_u32 s68, s68, s71
    s_sub_u32 s72, s72, 1
    s_cbranch_scc0 L_ck_26
    s_waitcnt vmcnt(24)
    s_mov_b64 exec, 1
    ds_add_u32 v15, v14 offset:4
    s_mov_b64 exec, -1
    s_mov_b32 s72, 18
L_ck_27:
    buffer_load_dwordx4 v5, s[52:55], s68 offen offset:0 nt lds
    s_add_u32 m0, m0, 32
    s_waitcnt vmcnt(33)
    buffer_load_dwordx4 v5, s[52:55], s68 offen offset:1024 nt lds
    s_add_u32 m0, m0, 32
    s_waitcnt vmcnt(33)
    buffer_load_dwordx4 v5, s[52:55], s68 offen offset:2048 nt lds
    s_add_u32 m0, m0, 32
    s_waitcnt vmcnt(33)
    buffer_load_dwordx4 v5, s[52:55], s68 offen offset:3072 nt lds
    s_add_u32 m0, m0, s73
    s_waitcnt vmcnt(33)
    s_add_u32 s68, s68, s71
    s_sub_u32 s72, s72, 1
    s_cbranch_scc0 L_ck_27
    s_mov_b64 exec, 1
    ds_add_u32 v15, v14 offset:4
    s_mov_b64 exec, -1
    s_mov_b32 s72, 6
L_ck_28:
    buffer_load_dwordx4 v5, s[52:55], s68 offen offset:0 nt lds
    s_add_u32 m0, m0, 32
    s_waitcnt vmcnt(33)
    buffer_load_dwordx4 v5, s[52:55], s68 offen offset:1024 nt lds
    s_add_u32 m0, m0, 32
    s_waitcnt vmcnt(33)
    buffer_load_dwordx4 v5, s[52:55], s68 offen offset:2048 nt lds
    s_add_u32 m0, m0, 32
    s_waitcnt vmcnt(33)
    buffer_load_dwordx4 v5, s[52:55], s68 offen offset:3072 nt lds
    s_add_u32 m0, m0, s73
    s_waitcnt vmcnt(33)
    s_add_u32 s68, s68, s71
    s_sub_u32 s72, s72, 1
    s_cbranch_scc0 L_ck_28
    s_waitcnt vmcnt(20) lgkmcnt(0)
    s_barrier
    s_waitcnt vmcnt(0)
    s_barrier
    s_setprio 0
    s_load_dword s44, s[32:33], 0
    s_mov_b64 s[56:57], s[18:19]
    s_lshl_b32 s69, s36, 17
    s_lshl_b32 s70, s37, 7
    s_add_u32 s69, s69, s70
    s_mul_i32 s74, s37, 2688
    s_add_u32 s74, s74, 1052672
    v_lshrrev_b32 v6, 3, v0
    v_and_b32 v7, 2, v6
    v_xor_b32 v7, v7, v4
    v_lshlrev_b32 v6, 10, v6
    v_lshl_add_u32 v6, v7, 4, v6
    v_lshlrev_b32_e64 v8, 2, v1
    s_mov_b32 m0, 45824
    s_mov_b32 s73, 1088
    s_mov_b32 s71, 8192
    s_mov_b32 s72, 65536
    s_barrier
    s_waitcnt lgkmcnt(0)
    s_barrier
    s_barrier
    s_add_u32 s44, s44, 1
    s_and_b32 s45, s44, 0xff
    s_mul_i32 s46, s44, 0x3c6ef362
    s_or_b32 s46, s46, 1
    s_mov_b32 s47, 0xffffff00
    s_mov_b32 s48, 0x05040100
    s_mov_b32 s49, 0x07060302
L_fw_29:
    ds_read_b32 v13, v15 offset:12
    s_waitcnt lgkmcnt(0)
    v_cmp_gt_u32_e64 vcc, 4, v13
    s_nop 0
    s_cbranch_vccnz L_fw_29
    s_setprio 3
    buffer_load_dword v9, v8, s[60:63], s74 offen offset:2560 sc1
    buffer_load_dwordx4 v6, s[56:59], s69 offen nt lds
    s_add_u32 m0, m0, s73
    s_add_u32 s69, s69, s71
    buffer_load_dwordx4 v6, s[56:59], s69 offen nt lds
    s_add_u32 m0, m0, s73
    s_add_u32 s69, s69, s71
    buffer_load_dwordx4 v6, s[56:59], s69 offen nt lds
    s_add_u32 m0, m0, s73
    s_add_u32 s69, s69, s71
    buffer_load_dwordx4 v6, s[56:59], s69 offen nt lds
    s_add_u32 m0, m0, s73
    s_add_u32 s69, s69, s71
    buffer_load_dwordx4 v6, s[56:59], s69 offen nt lds
    s_add_u32 m0, m0, s73
    s_add_u32 s69, s69, s71
    buffer_load_dwordx4 v6, s[56:59], s69 offen nt lds
    s_add_u32 m0, m0, s73
    s_add_u32 s69, s69, s71
    buffer_load_dwordx4 v6, s[56:59], s69 offen nt lds
    s_add_u32 m0, m0, s73
    s_add_u32 s69, s69, s71
    buffer_load_dwordx4 v6, s[56:59], s69 offen nt lds
    s_add_u32 m0, m0, s73
    s_add_u32 s69, s69, s71
    buffer_load_dwordx4 v6, s[56:59], s69 offen nt lds
    s_add_u32 m0, m0, s73
    s_add_u32 s69, s69, s71
    buffer_load_dwordx4 v6, s[56:59], s69 offen nt lds
    s_add_u32 m0, m0, s73
    s_add_u32 s69, s69, s71
    buffer_load_dwordx4 v6, s[56:59], s69 offen nt lds
    s_add_u32 m0, m0, s73
    s_add_u32 s69, s69, s71
    buffer_load_dwordx4 v6, s[56:59], s69 offen nt lds
    s_add_u32 m0, m0, s73
    s_add_u32 s69, s69, s71
    buffer_load_dwordx4 v6, s[56:59], s69 offen nt lds
    s_add_u32 m0, m0, s73
    s_add_u32 s69, s69, s71
    buffer_load_dwordx4 v6, s[56:59], s69 offen nt lds
    s_add_u32 m0, m0, s73
    s_add_u32 s69, s69, s71
    buffer_load_dwordx4 v6, s[56:59], s69 offen nt lds
    s_add_u32 m0, m0, s73
    s_add_u32 s69, s69, s71
    buffer_load_dwordx4 v6, s[56:59], s69 offen nt lds
    s_waitcnt vmcnt(16)
    v_cmp_ne_u32 vcc, s46, v9
    s_nop 0
    s_cbranch_vccnz L_ac_30
L_ac_31:
    s_waitcnt vmcnt(0)
    s_mov_b64 exec, 1
    ds_add_u32 v15, v14 offset:28
    s_mov_b64 exec, -1
    s_endpgm
L_ac_30:
    s_sub_u32 s72, s72, 1
    s_cbranch_scc1 L_ac_31
L_PAD11:
    s_cbranch_execz L_PAD12
    s_nop 0
    buffer_load_dword v9, v8, s[60:63], s74 offen offset:2560 sc1
    s_waitcnt vmcnt(0)
    v_cmp_ne_u32 vcc, s46, v9
    s_nop 0
    s_cbranch_vccnz L_ac_30
    s_branch L_ac_31
L_WF:
    v_mov_b32 v14, 0
    v_mov_b32 v13, 0xff800000
    v_lshlrev_b32_e64 v6, 2, v1
    ds_write_b32 v6, v14 offset:27664
    ds_write_b32 v6, v13 offset:27728
    ds_write_b32 v6, v14 offset:27520
    ds_write_b32 v6, v14 offset:27584
    s_mov_b64 s[60:61], s[32:33]
    s_mov_b32 s62, 9179136
    s_mov_b32 s63, 0x20000
    s_mov_b64 s[56:57], s[26:27]
    s_mov_b32 s58, 1835008
    s_mov_b32 s59, 0x20000
    v_lshlrev_b32_e64 v7, 4, v4
    v_lshl_add_u32 v6, v3, 2, v2
    v_lshl_add_u32 v8, v6, 13, v7
    s_lshl_b32 s4, s43, 16
    s_lshl_b32 s70, s37, 7
    s_add_u32 s4, s4, s70
    s_waitcnt lgkmcnt(0)
    s_barrier
    s_load_dword s44, s[32:33], 0
    s_mov_b64 exec, 0
    s_branch L_CHAIN_F
L_BACK_F:
    s_mov_b64 exec, -1
    s_cmp_lt_u32 s43, 28
    s_cbranch_scc1 L_FGO
L_fw_32:
    ds_read_b32 v14, v15 offset:8
    s_waitcnt lgkmcnt(0)
    v_cmp_gt_u32 vcc, 1, v14
    s_nop 0
    s_cbranch_vccnz L_fw_32
    v_mov_b32 v248, 0
    v_mov_b32 v249, 0
    v_mov_b32 v250, 0
    v_mov_b32 v251, 0
    s_nop 0
    s_branch L_FOUT
L_FGO:
    s_waitcnt lgkmcnt(0)
    s_add_u32 s44, s44, 1
    s_and_b32 s45, s44, 0xff
    s_mul_i32 s46, s44, 0x3c6ef362
    s_or_b32 s46, s46, 1
    s_mov_b32 s47, 0xffffff00
    s_mov_b32 s48, 0x05040100
    s_mov_b32 s49, 0x07060302
    s_xor_b32 s45, s45, 0x80
    v_mov_b32 v12, s45
    s_cmp_eq_u32 s39, 0
    s_cselect_b64 s[52:53], s[22:23], s[24:25]
    s_mov_b32 s54, 1835008
    s_mov_b32 s55, 0x20000
    s_mov_b64 s[64:65], s[8:9]
    s_mov_b32 s66, 4096
    s_mov_b32 s67, 0x20000
    s_lshl_b32 s5, s43, 12
    s_lshl_b32 s70, s37, 7
    s_add_u32 s5, s5, s70
    v_lshl_add_u32 v252, v2, 10, v7
    v_lshl_add_u32 v252, v3, 3, v252
    v_and_b32 v9, 1, v1
    v_lshlrev_b32 v9, 6, v9
    v_lshl_add_u32 v9, v2, 4, v9
    v_lshrrev_b32_e64 v10, 2, v1
    v_mul_u32_u24 v11, 1056, v10
    s_lshl_b32 s70, s38, 8
    v_add3_u32 v11, v11, v9, s70
    v_mul_u32_u24 v10, 144, v10
    v_add_u32 v10, v10, v9
    v_mul_u32_u24 v9, 144, v2
    v_lshl_add_u32 v9, v4, 4, v9
    v_lshl_add_u32 v9, v3, 3, v9
    v_mul_u32_u24 v6, 28672, v6
    v_add_u32_e64 v6, v6, v7
    s_mul_i32 s75, s38, 458752
    s_lshl_b32 s70, s43, 7
    s_add_u32 s75, s75, s70
    s_lshl_b32 s68, s36, 13
    s_add_u32 s68, s68, 4096
    s_add_u32 s69, s68, 4096
    s_lshl_b32 s6, s37, 10
    s_add_u32 s6, s6, s68
    s_mov_b32 s73, 3584
    s_barrier
    s_barrier
    buffer_load_dwordx2 v[60:61], v252, s[64:67], s5 offen
    buffer_load_dwordx4 v[64:67], v6, s[52:55], s75 offen nt
    s_add_u32 s75, s75, s73
    buffer_load_dwordx4 v[68:71], v6, s[52:55], s75 offen nt
    s_add_u32 s75, s75, s73
    buffer_load_dwordx4 v[72:75], v6, s[52:55], s75 offen nt
    s_add_u32 s75, s75, s73
    buffer_load_dwordx4 v[76:79], v6, s[52:55], s75 offen nt
    s_add_u32 s75, s75, s73
    buffer_load_dwordx4 v[80:83], v6, s[52:55], s75 offen nt
    s_add_u32 s75, s75, s73
    buffer_load_dwordx4 v[84:87], v6, s[52:55], s75 offen nt
    s_add_u32 s75, s75, s73
    buffer_load_dwordx4 v[88:91], v6, s[52:55], s75 offen nt
    s_add_u32 s75, s75, s73
    buffer_load_dwordx4 v[92:95], v6, s[52:55], s75 offen nt
    s_add_u32 s75, s75, 204288
    buffer_load_dwordx4 v[96:99], v6, s[52:55], s75 offen nt
    s_add_u32 s75, s75, s73
    buffer_load_dwordx4 v[100:103], v6, s[52:55], s75 offen nt
    s_add_u32 s75, s75, s73
    buffer_load_dwordx4 v[104:107], v6, s[52:55], s75 offen nt
    s_add_u32 s75, s75, s73
    buffer_load_dwordx4 v[108:111], v6, s[52:55], s75 offen nt
    s_add_u32 s75, s75, s73
    buffer_load_dwordx4 v[112:115], v6, s[52:55], s75 offen nt
    s_add_u32 s75, s75, s73
    buffer_load_dwordx4 v[116:119], v6, s[52:55], s75 offen nt
    s_add_u32 s75, s75, s73
    buffer_load_dwordx4 v[120:123], v6, s[52:55], s75 offen nt
    s_add_u32 s75, s75, s73
    buffer_load_dwordx4 v[124:127], v6, s[52:55], s75 offen nt
    ds_read_b128 v[240:243], v11 offset:16896
    ds_read_b128 v[244:247], v11 offset:17024
    ds_read_b32 v14, v15 offset:8
    s_mov_b32 s73, 1024
    s_barrier
    buffer_load_dwordx4 v[160:163], v8, s[56:59], s4 offen nt
    s_add_u32 s4, s4, s73
    buffer_load_dwordx4 v[164:167], v8, s[56:59], s4 offen nt
    s_add_u32 s4, s4, s73
    buffer_load_dwordx4 v[168:171], v8, s[56:59], s4 offen nt
    s_add_u32 s4, s4, s73
    buffer_load_dwordx4 v[172:175], v8, s[56:59], s4 offen nt
    s_add_u32 s4, s4, s73
    buffer_load_dwordx4 v[176:179], v8, s[56:59], s4 offen nt
    s_add_u32 s4, s4, s73
    buffer_load_dwordx4 v[180:183], v8, s[56:59], s4 offen nt
    s_add_u32 s4, s4, s73
    buffer_load_dwordx4 v[184:187], v8, s[56:59], s4 offen nt
    s_add_u32 s4, s4, s73
    buffer_load_dwordx4 v[188:191], v8, s[56:59], s4 offen nt
    s_barrier
    s_barrier
    s_waitcnt vmcnt(16) lgkmcnt(0)
    v_readfirstlane_b32 s50, v14
    s_nop 0
    s_sub_u32 s50, s50, 1
    s_nop 0
    v_perm_b32 v192, v68, v64, s48
    v_perm_b32 v193, v76, v72, s48
    v_perm_b32 v194, v84, v80, s48
    v_perm_b32 v195, v92, v88, s48
    v_perm_b32 v196, v68, v64, s49
    v_perm_b32 v197, v76, v72, s49
    v_perm_b32 v198, v84, v80, s49
    v_perm_b32 v199, v92, v88, s49
    v_mfma_f32_16x16x32_bf16 v[208:211], v[240:243], v[192:195], 0
    v_perm_b32 v200, v69, v65, s48
    v_perm_b32 v201, v77, v73, s48
    v_perm_b32 v202, v85, v81, s48
    v_perm_b32 v203, v93, v89, s48
    v_mfma_f32_16x16x32_bf16 v[212:215], v[240:243], v[196:199], 0
    v_perm_b32 v204, v69, v65, s49
    v_perm_b32 v205, v77, v73, s49
L_PAD12:
    s_cbranch_execz L_PAD13
    s_nop 0
    v_perm_b32 v206, v85, v81, s49
    v_perm_b32 v207, v93, v89, s49
    v_mfma_f32_16x16x32_bf16 v[216:219], v[240:243], v[200:203], 0
    v_perm_b32 v192, v70, v66, s48
    v_perm_b32 v193, v78, v74, s48
    v_perm_b32 v194, v86, v82, s48
    v_perm_b32 v195, v94, v90, s48
    v_mfma_f32_16x16x32_bf16 v[220:223], v[240:243], v[204:207], 0
    v_perm_b32 v196, v70, v66, s49
    v_perm_b32 v197, v78, v74, s49
    v_perm_b32 v198, v86, v82, s49
    v_perm_b32 v199, v94, v90, s49
    v_mfma_f32_16x16x32_bf16 v[224:227], v[240:243], v[192:195], 0
    v_perm_b32 v200, v71, v67, s48
    v_perm_b32 v201, v79, v75, s48
    v_perm_b32 v202, v87, v83, s48
    v_perm_b32 v203, v95, v91, s48
    v_mfma_f32_16x16x32_bf16 v[228:231], v[240:243], v[196:199], 0
    v_perm_b32 v204, v71, v67, s49
    v_perm_b32 v205, v79, v75, s49
    v_perm_b32 v206, v87, v83, s49
    v_perm_b32 v207, v95, v91, s49
    v_mfma_f32_16x16x32_bf16 v[232:235], v[240:243], v[200:203], 0
    s_nop 0
    v_mfma_f32_16x16x32_bf16 v[236:239], v[240:243], v[204:207], 0
    s_waitcnt vmcnt(8)
    v_perm_b32 v192, v100, v96, s48
    v_perm_b32 v193, v108, v104, s48
    v_perm_b32 v194, v116, v112, s48
    v_perm_b32 v195, v124, v120, s48
    v_perm_b32 v196, v100, v96, s49
    v_perm_b32 v197, v108, v104, s49
    v_perm_b32 v198, v116, v112, s49
    v_perm_b32 v199, v124, v120, s49
    v_mfma_f32_16x16x32_bf16 v[208:211], v[244:247], v[192:195], v[208:211]
    v_perm_b32 v200, v101, v97, s48
    v_perm_b32 v201, v109, v105, s48
    v_perm_b32 v202, v117, v113, s48
    v_perm_b32 v203, v125, v121, s48
    v_mfma_f32_16x16x32_bf16 v[212:215], v[244:247], v[196:199], v[212:215]
    v_perm_b32 v204, v101, v97, s49
    v_perm_b32 v205, v109, v105, s49
    v_perm_b32 v206, v117, v113, s49
    v_perm_b32 v207, v125, v121, s49
    v_mfma_f32_16x16x32_bf16 v[216:219], v[244:247], v[200:203], v[216:219]
    v_perm_b32 v192, v102, v98, s48
    v_perm_b32 v193, v110, v106, s48
    v_perm_b32 v194, v118, v114, s48
    v_perm_b32 v195, v126, v122, s48
    v_mfma_f32_16x16x32_bf16 v[220:223], v[244:247], v[204:207], v[220:223]
    v_perm_b32 v196, v102, v98, s49
    v_perm_b32 v197, v110, v106, s49
    v_perm_b32 v198, v118, v114, s49
    v_perm_b32 v199, v126, v122, s49
    v_mfma_f32_16x16x32_bf16 v[224:227], v[244:247], v[192:195], v[224:227]
    v_perm_b32 v200, v103, v99, s48
    v_perm_b32 v201, v111, v107, s48
    v_perm_b32 v202, v119, v115, s48
    v_perm_b32 v203, v127, v123, s48
    v_mfma_f32_16x16x32_bf16 v[228:231], v[244:247], v[196:199], v[228:231]
    v_perm_b32 v204, v103, v99, s49
    v_perm_b32 v205, v111, v107, s49
    v_perm_b32 v206, v119, v115, s49
    v_perm_b32 v207, v127, v123, s49
    v_mfma_f32_16x16x32_bf16 v[232:235], v[244:247], v[200:203], v[232:235]
    s_nop 0
    s_nop 0
    v_mfma_f32_16x16x32_bf16 v[236:239], v[244:247], v[204:207], v[236:239]
    v_add_f32_dpp v248, v209, v208 row_ror:8 row_mask:0xf bank_mask:0x3
    v_add_f32_dpp v249, v213, v212 row_ror:8 row_mask:0xf bank_mask:0x3
    v_add_f32_dpp v250, v217, v216 row_ror:8 row_mask:0xf bank_mask:0x3
    v_add_f32_dpp v251, v221, v220 row_ror:8 row_mask:0xf bank_mask:0x3
    v_add_f32_dpp v248, v224, v225 row_ror:8 row_mask:0xf bank_mask:0xc
    v_add_f32_dpp v249, v228, v229 row_ror:8 row_mask:0xf bank_mask:0xc
    v_add_f32_dpp v250, v232, v233 row_ror:8 row_mask:0xf bank_mask:0xc
    s_nop 0
    v_add_f32_dpp v251, v236, v237 row_ror:8 row_mask:0xf bank_mask:0xc
    s_cmp_eq_u32 s50, 0
    v_and_or_b32 v248, v248, s47, v12
    v_and_or_b32 v249, v249, s47, v12
    v_and_or_b32 v250, v250, s47, v12
    v_and_or_b32 v251, v251, s47, v12
    s_nop 0
    s_cbranch_scc0 L_pl_33
    buffer_store_dwordx4 v[248:251], v5, s[60:63], s6 offen
L_pl_34:
    s_mov_b32 s72, 65536
    s_waitcnt vmcnt(0)
    s_nop 0
    buffer_load_dwordx4 v[16:19], v5, s[60:63], s68 offen offset:0 sc1
    buffer_load_dwordx4 v[20:23], v5, s[60:63], s68 offen offset:1024 sc1
    buffer_load_dwordx4 v[24:27], v5, s[60:63], s68 offen offset:2048 sc1
    buffer_load_dwordx4 v[28:31], v5, s[60:63], s68 offen offset:3072 sc1
    buffer_load_dwordx4 v[32:35], v5, s[60:63], s69 offen offset:0 sc1
    buffer_load_dwordx4 v[36:39], v5, s[60:63], s69 offen offset:1024 sc1
    buffer_load_dwordx4 v[40:43], v5, s[60:63], s69 offen offset:2048 sc1
    buffer_load_dwordx4 v[44:47], v5, s[60:63], s69 offen offset:3072 sc1
    v_perm_b32 v128, v164, v160, s48
    v_perm_b32 v129, v172, v168, s48
    v_perm_b32 v130, v180, v176, s48
    v_perm_b32 v131, v188, v184, s48
    v_perm_b32 v132, v164, v160, s49
    v_perm_b32 v133, v172, v168, s49
    v_perm_b32 v134, v180, v176, s49
    v_perm_b32 v135, v188, v184, s49
    v_perm_b32 v136, v165, v161, s48
    v_perm_b32 v137, v173, v169, s48
    v_perm_b32 v138, v181, v177, s48
    v_perm_b32 v139, v189, v185, s48
    v_perm_b32 v140, v165, v161, s49
    v_perm_b32 v141, v173, v169, s49
    v_perm_b32 v142, v181, v177, s49
    v_perm_b32 v143, v189, v185, s49
    v_perm_b32 v144, v166, v162, s48
    v_perm_b32 v145, v174, v170, s48
    v_perm_b32 v146, v182, v178, s48
    v_perm_b32 v147, v190, v186, s48
    v_perm_b32 v148, v166, v162, s49
    v_perm_b32 v149, v174, v170, s49
    v_perm_b32 v150, v182, v178, s49
    v_perm_b32 v151, v190, v186, s49
    v_perm_b32 v152, v167, v163, s48
    v_perm_b32 v153, v175, v171, s48
    v_perm_b32 v154, v183, v179, s48
    v_perm_b32 v155, v191, v187, s48
    v_perm_b32 v156, v167, v163, s49
    v_perm_b32 v157, v175, v171, s49
    v_perm_b32 v158, v183, v179, s49
    v_perm_b32 v159, v191, v187, s49
    s_setprio 3
L_fg_35:
    s_waitcnt vmcnt(7)
    v_xor_b32 v16, v16, v12
    v_xor_b32 v17, v17, v12
    v_xor_b32 v18, v18, v12
    v_xor_b32 v19, v19, v12
    v_or_b32_e64 v13, v16, v17
L_PAD13:
    s_cbranch_execz L_PAD14
    s_nop 0
    v_or3_b32 v13, v13, v18, v19
    s_waitcnt vmcnt(6)
    v_xor_b32 v20, v20, v12
    v_xor_b32 v21, v21, v12
    v_xor_b32 v22, v22, v12
    v_xor_b32_e64 v23, v23, v12
    v_or3_b32 v13, v13, v20, v21
    v_or3_b32 v13, v13, v22, v23
    s_waitcnt vmcnt(5)
    v_xor_b32 v24, v24, v12
    v_xor_b32 v25, v25, v12
    v_xor_b32 v26, v26, v12
    v_xor_b32_e64 v27, v27, v12
    v_or3_b32 v13, v13, v24, v25
    v_or3_b32 v13, v13, v26, v27
    v_pk_add_f32 v[52:53], v[16:17], v[24:25]
    v_pk_add_f32 v[54:55], v[18:19], v[26:27]
    s_waitcnt vmcnt(4)
    v_xor_b32 v28, v28, v12
    v_xor_b32 v29, v29, v12
    v_xor_b32 v30, v30, v12
    v_xor_b32_e64 v31, v31, v12
    v_or3_b32 v13, v13, v28, v29
    v_or3_b32 v13, v13, v30, v31
    v_pk_add_f32 v[56:57], v[20:21], v[28:29]
    v_pk_add_f32 v[58:59], v[22:23], v[30:31]
    s_waitcnt vmcnt(3)
    v_xor_b32 v32, v32, v12
    v_xor_b32 v33, v33, v12
    v_xor_b32 v34, v34, v12
    v_xor_b32_e64 v35, v35, v12
    v_or3_b32 v13, v13, v32, v33
    v_or3_b32 v13, v13, v34, v35
    v_pk_add_f32 v[52:53], v[52:53], v[32:33]
    v_pk_add_f32 v[54:55], v[54:55], v[34:35]
    s_waitcnt vmcnt(2)
    v_xor_b32 v36, v36, v12
    v_xor_b32 v37, v37, v12
    v_xor_b32 v38, v38, v12
    v_xor_b32_e64 v39, v39, v12
    v_or3_b32 v13, v13, v36, v37
    v_or3_b32 v13, v13, v38, v39
    v_pk_add_f32 v[56:57], v[56:57], v[36:37]
    v_pk_add_f32 v[58:59], v[58:59], v[38:39]
    s_waitcnt vmcnt(1)
    v_xor_b32 v40, v40, v12
    v_xor_b32 v41, v41, v12
    v_xor_b32 v42, v42, v12
    v_xor_b32_e64 v43, v43, v12
    v_or3_b32 v13, v13, v40, v41
    v_or3_b32 v13, v13, v42, v43
    v_pk_add_f32 v[52:53], v[52:53], v[40:41]
    v_pk_add_f32 v[54:55], v[54:55], v[42:43]
    s_waitcnt vmcnt(0)
    v_xor_b32 v44, v44, v12
    v_xor_b32 v45, v45, v12
    v_xor_b32 v46, v46, v12
    v_xor_b32_e64 v47, v47, v12
    v_or3_b32 v13, v13, v44, v45
    v_or3_b32 v13, v13, v46, v47
    v_pk_add_f32 v[56:57], v[56:57], v[44:45]
    v_pk_add_f32 v[58:59], v[58:59], v[46:47]
    v_and_b32 v13, 0xff, v13
    v_cmp_ne_u32_e64 vcc, 0, v13
    s_nop 0
    s_cbranch_vccz L_fgd_36
    s_sub_u32 s72, s72, 1
    s_cbranch_scc1 L_fgd_36
    buffer_load_dwordx4 v[16:19], v5, s[60:63], s68 offen offset:0 sc1
    buffer_load_dwordx4 v[20:23], v5, s[60:63], s68 offen offset:1024 sc1
    buffer_load_dwordx4 v[24:27], v5, s[60:63], s68 offen offset:2048 sc1
    buffer_load_dwordx4 v[28:31], v5, s[60:63], s68 offen offset:3072 sc1
    buffer_load_dwordx4 v[32:35], v5, s[60:63], s69 offen offset:0 sc1
    buffer_load_dwordx4 v[36:39], v5, s[60:63], s69 offen offset:1024 sc1
    buffer_load_dwordx4 v[40:43], v5, s[60:63], s69 offen offset:2048 sc1
    buffer_load_dwordx4 v[44:47], v5, s[60:63], s69 offen offset:3072 sc1
    s_branch L_fg_35
L_fgd_36:
    s_nop 0
    v_cvt_pk_bf16_f32 v24, v52, v56
    v_cvt_pk_bf16_f32 v25, v53, v57
    v_cvt_pk_bf16_f32 v26, v54, v58
    v_cvt_pk_bf16_f32 v27, v55, v59
    s_mov_b32 s70, 0xbdd2d3e8
    v_mov_b32 v14, 0xc0135761
    v_lshlrev_b32_e64 v16, 16, v24
    v_and_b32 v20, 0xffff0000, v24
    v_lshlrev_b32_e64 v17, 16, v25
    v_and_b32 v21, 0xffff0000, v25
    v_lshlrev_b32_e64 v18, 16, v26
    v_and_b32 v22, 0xffff0000, v26
    v_lshlrev_b32_e64 v19, 16, v27
    v_and_b32 v23, 0xffff0000, v27
    v_mul_f32 v24, v16, v16
    v_mul_f32 v25, v17, v17
    v_mul_f32 v26, v18, v18
    v_mul_f32 v27, v19, v19
    v_fma_f32 v24, v24, s70, v14
    v_fma_f32 v25, v25, s70, v14
    v_fma_f32 v26, v26, s70, v14
    v_fma_f32 v27, v27, s70, v14
    v_mul_f32 v24, v24, v16
    v_mul_f32 v25, v25, v17
    v_mul_f32 v26, v26, v18
    v_mul_f32 v27, v27, v19
    v_exp_f32 v24, v24
    v_exp_f32 v25, v25
    v_exp_f32 v26, v26
    v_exp_f32 v27, v27
    v_add_f32 v24, 1.0, v24
    v_add_f32 v25, 1.0, v25
    v_add_f32 v26, 1.0, v26
    v_add_f32 v27, 1.0, v27
    v_rcp_f32 v24, v24
    v_rcp_f32 v25, v25
    v_rcp_f32 v26, v26
    v_rcp_f32 v27, v27
    v_mul_f32 v16, v16, v24
    v_mul_f32 v17, v17, v25
    v_mul_f32 v18, v18, v26
    v_mul_f32 v19, v19, v27
    v_cvt_pk_bf16_f32 v24, v16, v17
    v_cvt_pk_bf16_f32 v25, v18, v19
    v_lshlrev_b32_e64 v16, 16, v24
    v_and_b32 v17, 0xffff0000, v24
    v_lshlrev_b32_e64 v18, 16, v25
    v_and_b32 v19, 0xffff0000, v25
    v_mul_f32 v16, v16, v20
    v_mul_f32 v17, v17, v21
    v_mul_f32 v18, v18, v22
    v_mul_f32 v19, v19, v23
    v_cvt_pk_bf16_f32 v16, v16, v17
    v_cvt_pk_bf16_f32 v17, v18, v19
    ds_write_b64 v9, v[16:17] offset:26368
    ds_read_b128 v[240:243], v10 offset:26368
    s_waitcnt lgkmcnt(0)
    s_nop 0
    v_mfma_f32_16x16x32_bf16 v[208:211], v[240:243], v[128:131], 0
    v_mfma_f32_16x16x32_bf16 v[212:215], v[240:243], v[132:135], 0
    v_mfma_f32_16x16x32_bf16 v[216:219], v[240:243], v[136:139], 0
    v_mfma_f32_16x16x32_bf16 v[220:223], v[240:243], v[140:143], 0
    v_mfma_f32_16x16x32_bf16 v[224:227], v[240:243], v[144:147], 0
    v_mfma_f32_16x16x32_bf16 v[228:231], v[240:243], v[148:151], 0
    v_mfma_f32_16x16x32_bf16 v[232:235], v[240:243], v[152:155], 0
    v_mfma_f32_16x16x32_bf16 v[236:239], v[240:243], v[156:159], 0
    s_nop 0
    s_nop 0
    v_add_f32_dpp v248, v209, v208 row_ror:8 row_mask:0xf bank_mask:0x3
    v_add_f32_dpp v249, v213, v212 row_ror:8 row_mask:0xf bank_mask:0x3
    v_add_f32_dpp v250, v217, v216 row_ror:8 row_mask:0xf bank_mask:0x3
    v_add_f32_dpp v251, v221, v220 row_ror:8 row_mask:0xf bank_mask:0x3
    v_add_f32_dpp v248, v224, v225 row_ror:8 row_mask:0xf bank_mask:0xc
    v_add_f32_dpp v249, v228, v229 row_ror:8 row_mask:0xf bank_mask:0xc
    v_add_f32_dpp v250, v232, v233 row_ror:8 row_mask:0xf bank_mask:0xc
    v_add_f32_dpp v251, v236, v237 row_ror:8 row_mask:0xf bank_mask:0xc
    v_lshlrev_b32_e64 v16, 16, v60
    v_and_b32 v17, 0xffff0000, v60
    v_lshlrev_b32_e64 v18, 16, v61
    v_and_b32 v19, 0xffff0000, v61
    v_pk_add_f32 v[248:249], v[248:249], v[16:17]
    v_pk_add_f32 v[250:251], v[250:251], v[18:19]
L_FOUT:
L_PAD14:
    s_cbranch_execz L_BACK_F
    s_nop 0
    v_mov_b32 v14, 1
    v_lshlrev_b32 v13, 7, v4
    v_lshl_add_u32 v13, v3, 6, v13
    v_lshl_add_u32 v13, v2, 2, v13
    ds_write_b32 v13, v248 offset:16896
    ds_write_b32 v13, v249 offset:16912
    ds_write_b32 v13, v250 offset:16928
    ds_write_b32 v13, v251 offset:16944
    s_mov_b64 exec, 1
    ds_add_u32 v15, v14 offset:32
    s_endpgm
L_pl_33:
    buffer_store_dwordx4 v[248:251], v5, s[60:63], s6 offen sc1
    s_nop 0
    s_branch L_pl_34
L_CODE_END:
.section .rodata,"a"
.p2align 6
.amdhsa_kernel parallel_sum__compressed_kv_cla__glu_gated_geglu__decode_kernel
  .amdhsa_next_free_vgpr 256
  .amdhsa_next_free_sgpr 102
  .amdhsa_accum_offset 256
  .amdhsa_group_segment_fixed_size 0
  .amdhsa_kernarg_size 104
  .amdhsa_user_sgpr_count 2
  .amdhsa_user_sgpr_kernarg_segment_ptr 1
  .amdhsa_system_sgpr_workgroup_id_x 1
.end_amdhsa_kernel
```
